```python
import torch

def _softmax(x, axis=-1):
    return torch.softmax(x, dim=axis)
def _gelu(x):
    return torch.nn.functional.gelu(x, approximate="tanh")
def _silu(x):
    return torch.nn.functional.silu(x)
def _sigmoid(x):
    return torch.sigmoid(x)
def _layernorm(x, axis=-1, eps=1e-5):
    m = x.mean(dim=axis, keepdim=True)
    v = x.var(dim=axis, keepdim=True, unbiased=False)
    return (x - m) / torch.sqrt(v + eps)
def _scatter_add(tgt, idx, src, axis=0):
    return tgt.clone().index_add_(axis, idx, src)
def _segment_sum(src, seg, n):
    out = torch.zeros((n,) + src.shape[1:], dtype=src.dtype)
    return out.index_add_(0, seg, src)
def _pad(x, pw):
    flat = tuple(v for pair in reversed(pw) for v in pair)
    return torch.nn.functional.pad(x, flat)

kernel_name = 'standalone__molecular_angular_gemnet__graph'

def setup_inputs():

    _w = (lambda a: (lambda t: t.to(torch.bfloat16) if t.is_floating_point() else t)(torch.as_tensor(a)))
    N, deg, De, L = 25000, 32, 4, 2
    E = N * deg
    T = E * deg
    NR = 8
    dist = torch.rand(E).to(float)
    angle = (torch.rand(T) * torch.pi).to(float)
    centers = torch.linspace(0.0, 1.0, NR).to(float)
    ang_freq = torch.arange(1, L + 1).to(float)
    return {
        "m": _w((lambda *s: torch.randn(*s, dtype=torch.bfloat16) * 0.05)(E, De)),
        "idx_in": _w((lambda lo, hi, *s: torch.randint(lo, hi, s))(0, E, T).to(torch.int64)),
        "idx_out": _w((lambda lo, hi, *s: torch.randint(lo, hi, s))(0, E, T).to(torch.int64)),
        "dist": _w(dist),
        "angle": _w(angle),
        "centers": _w(centers),
        "ang_freq": _w(ang_freq),
        "w_rbf": _w((lambda *s: torch.randn(*s, dtype=torch.bfloat16) * 0.2)(NR, De)),
        "w_sbf": _w((lambda *s: torch.randn(*s, dtype=torch.bfloat16) * 0.2)(NR * L, De)),
        "w_down": _w((lambda *s: torch.randn(*s, dtype=torch.bfloat16) * 0.2)(De, De)),
        "w_up": _w((lambda *s: torch.randn(*s, dtype=torch.bfloat16) * 0.2)(De, De)),
    }

def reference(m, idx_in, idx_out, dist, angle, centers, ang_freq, w_rbf, w_sbf, w_down, w_up):
    E, De = m.shape[0], m.shape[1]
    NR = centers.shape[0]
    L = ang_freq.shape[0]
    rbf = torch.exp(-10.0 * (dist[:, None] - centers[None, :]) ** 2)
    cbf = torch.cos(ang_freq[None, :] * angle[:, None])
    rbf_t = rbf[idx_out]
    sbf = torch.reshape(rbf_t[:, :, None] * cbf[:, None, :], (-1, NR * L))
    x = (m[idx_in] @ w_down) * (sbf @ w_sbf)
    agg = _segment_sum(x, idx_out, E)
    return m + (agg @ w_up) * (rbf @ w_rbf)
```

```asm
; @launch kernel=prod_kernel grid=(256,1,1) block=(1024,1,1) lds=157760
; @launch kernel=cons_kernel grid=(256,1,1) block=(1024,1,1) lds=158080
.amdgcn_target "amdgcn-amd-amdhsa--gfx950"
.text
.globl prod_kernel
.p2align 8
.type prod_kernel,@function
prod_kernel:
  s_cmp_ge_u32 s2, 256
  s_cbranch_scc1 Lp_exit
  s_load_dwordx4 s[4:7], s[0:1], 0
  s_load_dwordx2 s[8:9], s[0:1], 16
  s_load_dwordx2 s[10:11], s[0:1], 32
  s_load_dwordx2 s[12:13], s[0:1], 72
  s_load_dwordx2 s[14:15], s[0:1], 104
  s_load_dwordx2 s[92:93], s[0:1], 96
  v_lshlrev_b32 v1, 4, v0
  v_mov_b32 v2, 6
  v_readfirstlane_b32 s67, v0
  s_mov_b32 s71, 1374390
  s_mov_b32 s72, 4294964171
  s_mov_b32 s73, 10737
  s_mov_b32 s74, 153600
  s_lshr_b32 s67, s67, 6
  s_waitcnt lgkmcnt(0)
  s_load_dwordx8 s[40:47], s[12:13], 0
  s_mov_b32 s16, s6
  s_and_b32 s17, s7, 0xffff
  s_mov_b32 s18, 102400000
  s_mov_b32 s19, 0x00020000
  s_mov_b32 s20, s8
  s_and_b32 s21, s9, 0xffff
  s_mov_b32 s22, 102400000
  s_mov_b32 s23, 0x00020000
  s_mov_b32 s24, s10
  s_and_b32 s25, s11, 0xffff
  s_mov_b32 s26, 51200000
  s_mov_b32 s27, 0x00020000
  s_mov_b32 s28, s14
  s_and_b32 s29, s15, 0xffff
  s_mov_b32 s30, 155648000
  s_mov_b32 s31, 0x00020000
  s_mov_b32 s32, s4
  s_and_b32 s33, s5, 0xffff
  s_mov_b32 s34, 6400000
  s_mov_b32 s35, 0x00020000
  s_mov_b32 s88, s92
  s_and_b32 s89, s93, 0xffff
  s_mov_b32 s90, 256
  s_mov_b32 s91, 0x00020000
  s_add_u32 s14, s14, 155648000
  s_addc_u32 s15, s15, 0
  s_mov_b32 s36, s14
  s_and_b32 s37, s15, 0xffff
  s_mov_b32 s38, 6400000
  s_mov_b32 s39, 0x00020000
  s_mov_b32 s64, s2
  s_add_u32 s65, s2, 256
  s_mov_b32 s75, 0
  s_mov_b32 s86, 4026531840
  s_cmp_lt_u32 s67, 6
  s_cselect_b32 s87, 0, 4026531840
  v_mov_b32 v119, 0
  v_lshlrev_b32 v120, 2, v0
  v_add_u32 v120, 153600, v120
  ds_write_b32 v120, v119
  s_mul_i32 s68, s64, 102400
  s_cmp_ge_u32 s2, 196
  s_cbranch_scc1 Lp_nomd
  s_lshl_b32 s3, s2, 15
  v_add_u32 v121, s3, v1
  v_add_u32 v122, 16384, v121
  buffer_load_dwordx4 v[52:55], v121, s[32:35], 0 offen
  buffer_load_dwordx4 v[56:59], v122, s[32:35], 0 offen
  s_add_u32 s66, s68, 0
  buffer_load_dwordx4 v[4:7], v1, s[20:23], s66 offen nt
  s_add_u32 s66, s68, 16384
  buffer_load_dwordx4 v[8:11], v1, s[20:23], s66 offen nt
  s_add_u32 s66, s68, 32768
  buffer_load_dwordx4 v[12:15], v1, s[20:23], s66 offen nt
  s_add_u32 s66, s68, 49152
  buffer_load_dwordx4 v[16:19], v1, s[20:23], s66 offen nt
  s_add_u32 s66, s68, 65536
  buffer_load_dwordx4 v[20:23], v1, s[20:23], s66 offen nt
  s_add_u32 s66, s68, 81920
  buffer_load_dwordx4 v[24:27], v1, s[20:23], s66 offen nt
  v_lshrrev_b32 v126, 2, v1
  s_add_u32 s66, s68, 98304
  buffer_load_dword v112, v126, s[20:23], s66 offen nt
  s_add_u32 s66, s68, 0
  buffer_load_dwordx4 v[28:31], v1, s[16:19], s66 offen nt
  s_add_u32 s66, s68, 16384
  buffer_load_dwordx4 v[32:35], v1, s[16:19], s66 offen nt
  s_add_u32 s66, s68, 32768
  buffer_load_dwordx4 v[36:39], v1, s[16:19], s66 offen nt
  s_add_u32 s66, s68, 49152
  buffer_load_dwordx4 v[40:43], v1, s[16:19], s66 offen nt
  s_add_u32 s66, s68, 65536
  buffer_load_dwordx4 v[44:47], v1, s[16:19], s66 offen nt
  s_add_u32 s66, s68, 81920
  buffer_load_dwordx4 v[48:51], v1, s[16:19], s66 offen nt
  v_lshrrev_b32 v126, 2, v1
  s_add_u32 s66, s68, 98304
  buffer_load_dword v113, v126, s[16:19], s66 offen nt
  s_mul_i32 s69, s64, 51200
  v_lshrrev_b32 v117, 1, v1
  v_lshrrev_b32 v118, 3, v1
  s_add_u32 s66, s69, 0
  buffer_load_dwordx2 v[100:101], v117, s[24:27], s66 offen nt
  s_add_u32 s66, s69, 8192
  buffer_load_dwordx2 v[102:103], v117, s[24:27], s66 offen nt
  s_add_u32 s66, s69, 16384
  buffer_load_dwordx2 v[104:105], v117, s[24:27], s66 offen nt
  s_add_u32 s66, s69, 24576
  buffer_load_dwordx2 v[106:107], v117, s[24:27], s66 offen nt
  s_add_u32 s66, s69, 32768
  buffer_load_dwordx2 v[108:109], v117, s[24:27], s66 offen nt
  s_add_u32 s66, s69, 40960
  buffer_load_dwordx2 v[110:111], v117, s[24:27], s66 offen nt
  s_add_u32 s66, s69, 49152
  buffer_load_ushort v116, v118, s[24:27], s66 offen nt
  s_waitcnt lgkmcnt(0)
  s_lshl_b32 s48, s40, 16
  s_and_b32 s49, s40, 0xffff0000
  s_lshl_b32 s50, s41, 16
  s_and_b32 s51, s41, 0xffff0000
  s_lshl_b32 s52, s42, 16
  s_and_b32 s53, s42, 0xffff0000
  s_lshl_b32 s54, s43, 16
  s_and_b32 s55, s43, 0xffff0000
  s_lshl_b32 s56, s44, 16
  s_and_b32 s57, s44, 0xffff0000
  s_lshl_b32 s58, s45, 16
  s_and_b32 s59, s45, 0xffff0000
  s_lshl_b32 s60, s46, 16
  s_and_b32 s61, s46, 0xffff0000
  s_lshl_b32 s62, s47, 16
  s_and_b32 s63, s47, 0xffff0000
  s_waitcnt vmcnt(21)
  v_lshlrev_b32 v76, 16, v52
  v_and_b32 v77, 0xffff0000, v52
  v_lshlrev_b32 v78, 16, v53
  v_and_b32 v79, 0xffff0000, v53
  v_mul_f32 v80, s48, v76
  v_mul_f32 v81, s49, v76
  v_mul_f32 v82, s50, v76
  v_mul_f32 v83, s51, v76
  v_fmac_f32 v80, s52, v77
  v_fmac_f32 v81, s53, v77
  v_fmac_f32 v82, s54, v77
  v_fmac_f32 v83, s55, v77
  v_fmac_f32 v80, s56, v78
  v_fmac_f32 v81, s57, v78
  v_fmac_f32 v82, s58, v78
  v_fmac_f32 v83, s59, v78
  v_fmac_f32 v80, s60, v79
  v_fmac_f32 v81, s61, v79
  v_fmac_f32 v82, s62, v79
  v_fmac_f32 v83, s63, v79
  v_cvt_pk_bf16_f32 v60, v80, v81
  v_cvt_pk_bf16_f32 v61, v82, v83
  v_lshlrev_b32 v76, 16, v54
  v_and_b32 v77, 0xffff0000, v54
  v_lshlrev_b32 v78, 16, v55
  v_and_b32 v79, 0xffff0000, v55
  v_mul_f32 v80, s48, v76
  v_mul_f32 v81, s49, v76
  v_mul_f32 v82, s50, v76
  v_mul_f32 v83, s51, v76
  v_fmac_f32 v80, s52, v77
  v_fmac_f32 v81, s53, v77
  v_fmac_f32 v82, s54, v77
  v_fmac_f32 v83, s55, v77
  v_fmac_f32 v80, s56, v78
  v_fmac_f32 v81, s57, v78
  v_fmac_f32 v82, s58, v78
  v_fmac_f32 v83, s59, v78
  v_fmac_f32 v80, s60, v79
  v_fmac_f32 v81, s61, v79
  v_fmac_f32 v82, s62, v79
  v_fmac_f32 v83, s63, v79
  v_cvt_pk_bf16_f32 v62, v80, v81
  v_cvt_pk_bf16_f32 v63, v82, v83
  v_lshlrev_b32 v76, 16, v56
  v_and_b32 v77, 0xffff0000, v56
  v_lshlrev_b32 v78, 16, v57
  v_and_b32 v79, 0xffff0000, v57
  v_mul_f32 v80, s48, v76
  v_mul_f32 v81, s49, v76
  v_mul_f32 v82, s50, v76
  v_mul_f32 v83, s51, v76
  v_fmac_f32 v80, s52, v77
  v_fmac_f32 v81, s53, v77
  v_fmac_f32 v82, s54, v77
  v_fmac_f32 v83, s55, v77
  v_fmac_f32 v80, s56, v78
  v_fmac_f32 v81, s57, v78
  v_fmac_f32 v82, s58, v78
  v_fmac_f32 v83, s59, v78
  v_fmac_f32 v80, s60, v79
  v_fmac_f32 v81, s61, v79
  v_fmac_f32 v82, s62, v79
  v_fmac_f32 v83, s63, v79
  v_cvt_pk_bf16_f32 v64, v80, v81
  v_cvt_pk_bf16_f32 v65, v82, v83
  v_lshlrev_b32 v76, 16, v58
  v_and_b32 v77, 0xffff0000, v58
  v_lshlrev_b32 v78, 16, v59
  v_and_b32 v79, 0xffff0000, v59
  v_mul_f32 v80, s48, v76
  v_mul_f32 v81, s49, v76
  v_mul_f32 v82, s50, v76
  v_mul_f32 v83, s51, v76
  v_fmac_f32 v80, s52, v77
  v_fmac_f32 v81, s53, v77
  v_fmac_f32 v82, s54, v77
  v_fmac_f32 v83, s55, v77
  v_fmac_f32 v80, s56, v78
  v_fmac_f32 v81, s57, v78
  v_fmac_f32 v82, s58, v78
  v_fmac_f32 v83, s59, v78
  v_fmac_f32 v80, s60, v79
  v_fmac_f32 v81, s61, v79
  v_fmac_f32 v82, s62, v79
  v_fmac_f32 v83, s63, v79
  v_cvt_pk_bf16_f32 v66, v80, v81
  v_cvt_pk_bf16_f32 v67, v82, v83
  buffer_store_dwordx4 v[60:63], v121, s[36:39], 0 offen sc1
  buffer_store_dwordx4 v[64:67], v122, s[36:39], 0 offen sc1
  s_branch Lp_start
Lp_nomd:
  s_add_u32 s66, s68, 0
  buffer_load_dwordx4 v[4:7], v1, s[20:23], s66 offen nt
  s_add_u32 s66, s68, 16384
  buffer_load_dwordx4 v[8:11], v1, s[20:23], s66 offen nt
  s_add_u32 s66, s68, 32768
  buffer_load_dwordx4 v[12:15], v1, s[20:23], s66 offen nt
  s_add_u32 s66, s68, 49152
  buffer_load_dwordx4 v[16:19], v1, s[20:23], s66 offen nt
  s_add_u32 s66, s68, 65536
  buffer_load_dwordx4 v[20:23], v1, s[20:23], s66 offen nt
  s_add_u32 s66, s68, 81920
  buffer_load_dwordx4 v[24:27], v1, s[20:23], s66 offen nt
  v_lshrrev_b32 v126, 2, v1
  s_add_u32 s66, s68, 98304
  buffer_load_dword v112, v126, s[20:23], s66 offen nt
  s_add_u32 s66, s68, 0
  buffer_load_dwordx4 v[28:31], v1, s[16:19], s66 offen nt
  s_add_u32 s66, s68, 16384
  buffer_load_dwordx4 v[32:35], v1, s[16:19], s66 offen nt
  s_add_u32 s66, s68, 32768
  buffer_load_dwordx4 v[36:39], v1, s[16:19], s66 offen nt
  s_add_u32 s66, s68, 49152
  buffer_load_dwordx4 v[40:43], v1, s[16:19], s66 offen nt
  s_add_u32 s66, s68, 65536
  buffer_load_dwordx4 v[44:47], v1, s[16:19], s66 offen nt
  s_add_u32 s66, s68, 81920
  buffer_load_dwordx4 v[48:51], v1, s[16:19], s66 offen nt
  v_lshrrev_b32 v126, 2, v1
  s_add_u32 s66, s68, 98304
  buffer_load_dword v113, v126, s[16:19], s66 offen nt
  s_mul_i32 s69, s64, 51200
  v_lshrrev_b32 v117, 1, v1
  v_lshrrev_b32 v118, 3, v1
  s_add_u32 s66, s69, 0
  buffer_load_dwordx2 v[100:101], v117, s[24:27], s66 offen nt
  s_add_u32 s66, s69, 8192
  buffer_load_dwordx2 v[102:103], v117, s[24:27], s66 offen nt
  s_add_u32 s66, s69, 16384
  buffer_load_dwordx2 v[104:105], v117, s[24:27], s66 offen nt
  s_add_u32 s66, s69, 24576
  buffer_load_dwordx2 v[106:107], v117, s[24:27], s66 offen nt
  s_add_u32 s66, s69, 32768
  buffer_load_dwordx2 v[108:109], v117, s[24:27], s66 offen nt
  s_add_u32 s66, s69, 40960
  buffer_load_dwordx2 v[110:111], v117, s[24:27], s66 offen nt
  s_add_u32 s66, s69, 49152
  buffer_load_ushort v116, v118, s[24:27], s66 offen nt
Lp_start:
  s_waitcnt lgkmcnt(0)
  s_barrier
Lp_body0:
  s_cmp_lt_u32 s65, 1000
  s_cselect_b32 s22, 102400000, 0
  s_cselect_b32 s18, 102400000, 0
  s_cselect_b32 s26, 51200000, 0
  s_min_u32 s66, s65, 1000
  s_mul_i32 s68, s66, 102400
  s_cmp_lg_u32 s67, 0
  s_cbranch_scc1 Lp_notk0
  s_mov_b64 exec, 1
  v_mov_b32 v3, 1
  v_mov_b32 v117, 192
  buffer_atomic_add v3, v117, s[88:91], 0 offen sc0
  s_mov_b64 exec, -1
Lp_notk0:
  v_or_b32 v127, s86, v1
  s_waitcnt lgkmcnt(0)
  s_add_u32 s66, s75, 0
  buffer_store_dwordx4 v[52:55], v127, s[28:31], s66 offen sc1
  s_add_u32 s66, s75, 16384
  buffer_store_dwordx4 v[56:59], v127, s[28:31], s66 offen sc1
  s_add_u32 s66, s75, 32768
  buffer_store_dwordx4 v[60:63], v127, s[28:31], s66 offen sc1
  s_add_u32 s66, s75, 49152
  buffer_store_dwordx4 v[64:67], v127, s[28:31], s66 offen sc1
  s_add_u32 s66, s75, 65536
  buffer_store_dwordx4 v[68:71], v127, s[28:31], s66 offen sc1
  s_add_u32 s66, s75, 81920
  buffer_store_dwordx4 v[72:75], v127, s[28:31], s66 offen sc1
  s_waitcnt vmcnt(13)
  v_mul_hi_u32_u24 v117, s71, v4
  v_mul_hi_u32_u24 v119, s73, v28
  v_mad_i32_i24 v118, v117, s72, v4
  v_lshl_add_u32 v117, v119, 8, v117
  v_lshl_or_b32 v28, v118, 20, v28
  v_lshl_add_u32 v4, v117, 2, s74
  ds_add_u32 v4, v2
  s_add_u32 s66, s75, 98304
  buffer_store_dwordx4 v[76:79], v127, s[28:31], s66 offen sc1
  v_mul_hi_u32_u24 v120, s71, v5
  v_mul_hi_u32_u24 v122, s73, v29
  v_mad_i32_i24 v121, v120, s72, v5
  v_lshl_add_u32 v120, v122, 8, v120
  v_lshl_or_b32 v29, v121, 20, v29
  v_lshl_add_u32 v5, v120, 2, s74
  ds_add_u32 v5, v2
  s_add_u32 s66, s75, 114688
  buffer_store_dwordx4 v[80:83], v127, s[28:31], s66 offen sc1
  v_mul_hi_u32_u24 v123, s71, v6
  v_mul_hi_u32_u24 v125, s73, v30
  v_mad_i32_i24 v124, v123, s72, v6
  v_lshl_add_u32 v123, v125, 8, v123
  v_lshl_or_b32 v30, v124, 20, v30
  v_lshl_add_u32 v6, v123, 2, s74
  ds_add_u32 v6, v2
  s_add_u32 s66, s75, 131072
  buffer_store_dwordx4 v[84:87], v127, s[28:31], s66 offen sc1
  v_mul_hi_u32_u24 v117, s71, v7
  v_mul_hi_u32_u24 v119, s73, v31
  v_mad_i32_i24 v118, v117, s72, v7
  v_lshl_add_u32 v117, v119, 8, v117
  v_lshl_or_b32 v31, v118, 20, v31
  v_lshl_add_u32 v7, v117, 2, s74
  ds_add_u32 v7, v2
  s_add_u32 s66, s75, 147456
  v_or_b32 v126, s87, v127
  buffer_store_dwordx4 v[88:91], v126, s[28:31], s66 offen sc1
  v_mul_hi_u32_u24 v120, s71, v8
  v_mul_hi_u32_u24 v122, s73, v32
  v_mad_i32_i24 v121, v120, s72, v8
  v_lshl_add_u32 v120, v122, 8, v120
  v_lshl_or_b32 v32, v121, 20, v32
  v_lshl_add_u32 v8, v120, 2, s74
  ds_add_u32 v8, v2
  v_mul_hi_u32_u24 v123, s71, v9
  v_mul_hi_u32_u24 v125, s73, v33
  v_mad_i32_i24 v124, v123, s72, v9
  v_lshl_add_u32 v123, v125, 8, v123
  v_lshl_or_b32 v33, v124, 20, v33
  v_lshl_add_u32 v9, v123, 2, s74
  ds_add_u32 v9, v2
  s_add_u32 s66, s68, 0
  buffer_load_dwordx4 v[52:55], v1, s[20:23], s66 offen nt
  v_mul_hi_u32_u24 v117, s71, v10
  v_mul_hi_u32_u24 v119, s73, v34
  v_mad_i32_i24 v118, v117, s72, v10
  v_lshl_add_u32 v117, v119, 8, v117
  v_lshl_or_b32 v34, v118, 20, v34
  v_lshl_add_u32 v10, v117, 2, s74
  ds_add_u32 v10, v2
  v_mul_hi_u32_u24 v120, s71, v11
  v_mul_hi_u32_u24 v122, s73, v35
  v_mad_i32_i24 v121, v120, s72, v11
  v_lshl_add_u32 v120, v122, 8, v120
  v_lshl_or_b32 v35, v121, 20, v35
  v_lshl_add_u32 v11, v120, 2, s74
  ds_add_u32 v11, v2
  v_mul_hi_u32_u24 v123, s71, v12
  v_mul_hi_u32_u24 v125, s73, v36
  v_mad_i32_i24 v124, v123, s72, v12
  v_lshl_add_u32 v123, v125, 8, v123
  v_lshl_or_b32 v36, v124, 20, v36
  v_lshl_add_u32 v12, v123, 2, s74
  ds_add_u32 v12, v2
  s_add_u32 s66, s68, 16384
  buffer_load_dwordx4 v[56:59], v1, s[20:23], s66 offen nt
  v_mul_hi_u32_u24 v117, s71, v13
  v_mul_hi_u32_u24 v119, s73, v37
  v_mad_i32_i24 v118, v117, s72, v13
  v_lshl_add_u32 v117, v119, 8, v117
  v_lshl_or_b32 v37, v118, 20, v37
  v_lshl_add_u32 v13, v117, 2, s74
  ds_add_u32 v13, v2
  v_mul_hi_u32_u24 v120, s71, v14
  v_mul_hi_u32_u24 v122, s73, v38
  v_mad_i32_i24 v121, v120, s72, v14
  v_lshl_add_u32 v120, v122, 8, v120
  v_lshl_or_b32 v38, v121, 20, v38
  v_lshl_add_u32 v14, v120, 2, s74
  ds_add_u32 v14, v2
  v_mul_hi_u32_u24 v123, s71, v15
  v_mul_hi_u32_u24 v125, s73, v39
  v_mad_i32_i24 v124, v123, s72, v15
  v_lshl_add_u32 v123, v125, 8, v123
  v_lshl_or_b32 v39, v124, 20, v39
  v_lshl_add_u32 v15, v123, 2, s74
  ds_add_u32 v15, v2
  s_add_u32 s66, s68, 32768
  buffer_load_dwordx4 v[60:63], v1, s[20:23], s66 offen nt
  v_mul_hi_u32_u24 v117, s71, v16
  v_mul_hi_u32_u24 v119, s73, v40
  v_mad_i32_i24 v118, v117, s72, v16
  v_lshl_add_u32 v117, v119, 8, v117
  v_lshl_or_b32 v40, v118, 20, v40
  v_lshl_add_u32 v16, v117, 2, s74
  ds_add_u32 v16, v2
  v_mul_hi_u32_u24 v120, s71, v17
  v_mul_hi_u32_u24 v122, s73, v41
  v_mad_i32_i24 v121, v120, s72, v17
  v_lshl_add_u32 v120, v122, 8, v120
  v_lshl_or_b32 v41, v121, 20, v41
  v_lshl_add_u32 v17, v120, 2, s74
  ds_add_u32 v17, v2
  v_mul_hi_u32_u24 v123, s71, v18
  v_mul_hi_u32_u24 v125, s73, v42
  v_mad_i32_i24 v124, v123, s72, v18
  v_lshl_add_u32 v123, v125, 8, v123
  v_lshl_or_b32 v42, v124, 20, v42
  v_lshl_add_u32 v18, v123, 2, s74
  ds_add_u32 v18, v2
  s_add_u32 s66, s68, 49152
  buffer_load_dwordx4 v[64:67], v1, s[20:23], s66 offen nt
  v_mul_hi_u32_u24 v117, s71, v19
  v_mul_hi_u32_u24 v119, s73, v43
  v_mad_i32_i24 v118, v117, s72, v19
  v_lshl_add_u32 v117, v119, 8, v117
  v_lshl_or_b32 v43, v118, 20, v43
  v_lshl_add_u32 v19, v117, 2, s74
  ds_add_u32 v19, v2
  v_mul_hi_u32_u24 v120, s71, v20
  v_mul_hi_u32_u24 v122, s73, v44
  v_mad_i32_i24 v121, v120, s72, v20
  v_lshl_add_u32 v120, v122, 8, v120
  v_lshl_or_b32 v44, v121, 20, v44
  v_lshl_add_u32 v20, v120, 2, s74
  ds_add_u32 v20, v2
  v_mul_hi_u32_u24 v123, s71, v21
  v_mul_hi_u32_u24 v125, s73, v45
  v_mad_i32_i24 v124, v123, s72, v21
  v_lshl_add_u32 v123, v125, 8, v123
  v_lshl_or_b32 v45, v124, 20, v45
  v_lshl_add_u32 v21, v123, 2, s74
  ds_add_u32 v21, v2
  s_add_u32 s66, s68, 65536
  buffer_load_dwordx4 v[68:71], v1, s[20:23], s66 offen nt
  v_mul_hi_u32_u24 v117, s71, v22
  v_mul_hi_u32_u24 v119, s73, v46
  v_mad_i32_i24 v118, v117, s72, v22
  v_lshl_add_u32 v117, v119, 8, v117
  v_lshl_or_b32 v46, v118, 20, v46
  v_lshl_add_u32 v22, v117, 2, s74
  ds_add_u32 v22, v2
  v_mul_hi_u32_u24 v120, s71, v23
  v_mul_hi_u32_u24 v122, s73, v47
  v_mad_i32_i24 v121, v120, s72, v23
  v_lshl_add_u32 v120, v122, 8, v120
  v_lshl_or_b32 v47, v121, 20, v47
  v_lshl_add_u32 v23, v120, 2, s74
  ds_add_u32 v23, v2
  v_mul_hi_u32_u24 v123, s71, v24
  v_mul_hi_u32_u24 v125, s73, v48
  v_mad_i32_i24 v124, v123, s72, v24
  v_lshl_add_u32 v123, v125, 8, v123
  v_lshl_or_b32 v48, v124, 20, v48
  v_lshl_add_u32 v24, v123, 2, s74
  ds_add_u32 v24, v2
  s_add_u32 s66, s68, 81920
  buffer_load_dwordx4 v[72:75], v1, s[20:23], s66 offen nt
  v_mul_hi_u32_u24 v117, s71, v25
  v_mul_hi_u32_u24 v119, s73, v49
  v_mad_i32_i24 v118, v117, s72, v25
  v_lshl_add_u32 v117, v119, 8, v117
  v_lshl_or_b32 v49, v118, 20, v49
  v_lshl_add_u32 v25, v117, 2, s74
  ds_add_u32 v25, v2
  v_mul_hi_u32_u24 v120, s71, v26
  v_mul_hi_u32_u24 v122, s73, v50
  v_mad_i32_i24 v121, v120, s72, v26
  v_lshl_add_u32 v120, v122, 8, v120
  v_lshl_or_b32 v50, v121, 20, v50
  v_lshl_add_u32 v26, v120, 2, s74
  ds_add_u32 v26, v2
  v_mul_hi_u32_u24 v123, s71, v27
  v_mul_hi_u32_u24 v125, s73, v51
  v_mad_i32_i24 v124, v123, s72, v27
  v_lshl_add_u32 v123, v125, 8, v123
  v_lshl_or_b32 v51, v124, 20, v51
  v_lshl_add_u32 v27, v123, 2, s74
  ds_add_u32 v27, v2
  v_lshrrev_b32 v126, 2, v1
  s_add_u32 s66, s68, 98304
  buffer_load_dword v114, v126, s[20:23], s66 offen nt
  v_mul_hi_u32_u24 v117, s71, v112
  v_mul_hi_u32_u24 v119, s73, v113
  v_mad_i32_i24 v118, v117, s72, v112
  v_lshl_add_u32 v117, v119, 8, v117
  v_lshl_or_b32 v113, v118, 20, v113
  v_lshl_add_u32 v112, v117, 2, s74
  ds_add_u32 v112, v2
  s_waitcnt lgkmcnt(0)
  s_barrier
  s_cmp_lg_u32 s67, 0
  s_cbranch_scc1 Lp_noscan0
  s_waitcnt vmcnt(17)
  v_mov_b32 v117, 157696
  s_mov_b64 exec, 1
  ds_write_b32 v117, v3
  s_mov_b64 exec, -1
  v_lshlrev_b32 v3, 5, v0
  v_add_u32 v3, 153600, v3
  ds_read_b128 v[120:123], v3
  ds_read_b128 v[124:127], v3 offset:16
  v_mov_b32 v118, 0
  v_mov_b32 v119, 0
  s_waitcnt lgkmcnt(0)
  ds_write_b64 v3, v[118:119] offset:0
  ds_write_b64 v3, v[118:119] offset:8
  ds_write_b64 v3, v[118:119] offset:16
  ds_write_b64 v3, v[118:119] offset:24
  v_add_u32 v121, v121, v120
  v_add_u32 v122, v122, v121
  v_add_u32 v123, v123, v122
  v_add_u32 v124, v124, v123
  v_add_u32 v125, v125, v124
  v_add_u32 v126, v126, v125
  v_add_u32 v127, v127, v126
  v_mov_b32 v117, v127
  s_nop 1
  v_add_u32_dpp v117, v117, v117 row_shr:1 row_mask:0xf bank_mask:0xf
  s_nop 1
  v_add_u32_dpp v117, v117, v117 row_shr:2 row_mask:0xf bank_mask:0xf
  s_nop 1
  v_add_u32_dpp v117, v117, v117 row_shr:4 row_mask:0xf bank_mask:0xf
  s_nop 1
  v_add_u32_dpp v117, v117, v117 row_shr:8 row_mask:0xf bank_mask:0xf
  s_nop 1
  v_add_u32_dpp v117, v117, v117 row_bcast:15 row_mask:0xa bank_mask:0xf
  s_nop 1
  v_add_u32_dpp v117, v117, v117 row_bcast:31 row_mask:0xc bank_mask:0xf
  s_waitcnt lgkmcnt(0)
  v_sub_u32 v118, v117, v127
  v_add_u32 v127, v118, v126
  v_add_u32 v126, v118, v125
  v_add_u32 v125, v118, v124
  v_add_u32 v124, v118, v123
  v_add_u32 v123, v118, v122
  v_add_u32 v122, v118, v121
  v_add_u32 v121, v118, v120
  v_mov_b32 v120, v118
  ds_write_b128 v3, v[120:123] offset:2048
  ds_write_b128 v3, v[124:127] offset:2064
  s_waitcnt lgkmcnt(0)
  v_lshrrev_b32 v120, 1, v120
  v_mul_u32_u24 v120, 43691, v120
  v_lshrrev_b32 v120, 17, v120
  v_lshrrev_b32 v121, 1, v121
  v_mul_u32_u24 v121, 43691, v121
  v_lshrrev_b32 v121, 17, v121
  v_lshrrev_b32 v122, 1, v122
  v_mul_u32_u24 v122, 43691, v122
  v_lshrrev_b32 v122, 17, v122
  v_lshrrev_b32 v123, 1, v123
  v_mul_u32_u24 v123, 43691, v123
  v_lshrrev_b32 v123, 17, v123
  v_lshrrev_b32 v124, 1, v124
  v_mul_u32_u24 v124, 43691, v124
  v_lshrrev_b32 v124, 17, v124
  v_lshrrev_b32 v125, 1, v125
  v_mul_u32_u24 v125, 43691, v125
  v_lshrrev_b32 v125, 17, v125
  v_lshrrev_b32 v126, 1, v126
  v_mul_u32_u24 v126, 43691, v126
  v_lshrrev_b32 v126, 17, v126
  v_lshrrev_b32 v127, 1, v127
  v_mul_u32_u24 v127, 43691, v127
  v_lshrrev_b32 v127, 17, v127
  v_lshrrev_b32 v117, 1, v117
  v_mul_u32_u24 v117, 43691, v117
  v_lshrrev_b32 v117, 17, v117
  v_sub_u32 v118, v121, v120
  v_lshl_or_b32 v120, v118, 16, v120
  v_sub_u32 v118, v122, v121
  v_lshl_or_b32 v121, v118, 16, v121
  v_sub_u32 v118, v123, v122
  v_lshl_or_b32 v122, v118, 16, v122
  v_sub_u32 v118, v124, v123
  v_lshl_or_b32 v123, v118, 16, v123
  v_sub_u32 v118, v125, v124
  v_lshl_or_b32 v124, v118, 16, v124
  v_sub_u32 v118, v126, v125
  v_lshl_or_b32 v125, v118, 16, v125
  v_sub_u32 v118, v127, v126
  v_lshl_or_b32 v126, v118, 16, v126
  v_sub_u32 v118, v117, v127
  v_lshl_or_b32 v127, v118, 16, v127
  s_mul_i32 s70, s64, 2048
  s_add_u32 s70, s70, 153600000
  v_lshl_add_u32 v117, v1, 1, s70
  buffer_store_dwordx4 v[120:123], v117, s[28:31], 0 offen sc1
  buffer_store_dwordx4 v[124:127], v117, s[28:31], 0 offen offset:16 sc1
Lp_noscan0:
  s_barrier
  ds_add_rtn_u32 v4, v4, v2 offset:2048
  ds_add_rtn_u32 v5, v5, v2 offset:2048
  ds_add_rtn_u32 v6, v6, v2 offset:2048
  ds_add_rtn_u32 v7, v7, v2 offset:2048
  s_add_u32 s66, s68, 0
  buffer_load_dwordx4 v[76:79], v1, s[16:19], s66 offen nt
  ds_add_rtn_u32 v8, v8, v2 offset:2048
  ds_add_rtn_u32 v9, v9, v2 offset:2048
  ds_add_rtn_u32 v10, v10, v2 offset:2048
  ds_add_rtn_u32 v11, v11, v2 offset:2048
  ds_add_rtn_u32 v12, v12, v2 offset:2048
  ds_add_rtn_u32 v13, v13, v2 offset:2048
  s_add_u32 s66, s68, 16384
  buffer_load_dwordx4 v[80:83], v1, s[16:19], s66 offen nt
  ds_add_rtn_u32 v14, v14, v2 offset:2048
  ds_add_rtn_u32 v15, v15, v2 offset:2048
  ds_add_rtn_u32 v16, v16, v2 offset:2048
  ds_add_rtn_u32 v17, v17, v2 offset:2048
  ds_add_rtn_u32 v18, v18, v2 offset:2048
  ds_add_rtn_u32 v19, v19, v2 offset:2048
  s_add_u32 s66, s68, 32768
  buffer_load_dwordx4 v[84:87], v1, s[16:19], s66 offen nt
  ds_add_rtn_u32 v20, v20, v2 offset:2048
  ds_add_rtn_u32 v21, v21, v2 offset:2048
  ds_add_rtn_u32 v22, v22, v2 offset:2048
  ds_add_rtn_u32 v23, v23, v2 offset:2048
  ds_add_rtn_u32 v24, v24, v2 offset:2048
  ds_add_rtn_u32 v25, v25, v2 offset:2048
  s_add_u32 s66, s68, 49152
  buffer_load_dwordx4 v[88:91], v1, s[16:19], s66 offen nt
  ds_add_rtn_u32 v26, v26, v2 offset:2048
  ds_add_rtn_u32 v27, v27, v2 offset:2048
  ds_add_rtn_u32 v112, v112, v2 offset:2048
  s_waitcnt vmcnt(21) lgkmcnt(0)
  v_and_b32 v117, 2, v4
  v_add_u32 v4, v4, v117
  ds_write_b32 v4, v28
  v_mul_u32_u24 v117, 3, v117
  v_sub_u32 v117, v4, v117
  ds_write_b16 v117, v100 offset:4
  v_and_b32 v118, 2, v5
  v_add_u32 v5, v5, v118
  ds_write_b32 v5, v29
  v_mul_u32_u24 v118, 3, v118
  v_sub_u32 v118, v5, v118
  ds_write_b16_d16_hi v118, v100 offset:4
  v_and_b32 v119, 2, v6
  v_add_u32 v6, v6, v119
  ds_write_b32 v6, v30
  v_mul_u32_u24 v119, 3, v119
  v_sub_u32 v119, v6, v119
  ds_write_b16 v119, v101 offset:4
  v_and_b32 v120, 2, v7
  v_add_u32 v7, v7, v120
  ds_write_b32 v7, v31
  v_mul_u32_u24 v120, 3, v120
  v_sub_u32 v120, v7, v120
  ds_write_b16_d16_hi v120, v101 offset:4
  v_and_b32 v121, 2, v8
  v_add_u32 v8, v8, v121
  ds_write_b32 v8, v32
  v_mul_u32_u24 v121, 3, v121
  v_sub_u32 v121, v8, v121
  ds_write_b16 v121, v102 offset:4
  s_add_u32 s66, s68, 65536
  buffer_load_dwordx4 v[92:95], v1, s[16:19], s66 offen nt
  v_and_b32 v122, 2, v9
  v_add_u32 v9, v9, v122
  ds_write_b32 v9, v33
  v_mul_u32_u24 v122, 3, v122
  v_sub_u32 v122, v9, v122
  ds_write_b16_d16_hi v122, v102 offset:4
  v_and_b32 v123, 2, v10
  v_add_u32 v10, v10, v123
  ds_write_b32 v10, v34
  v_mul_u32_u24 v123, 3, v123
  v_sub_u32 v123, v10, v123
  ds_write_b16 v123, v103 offset:4
  v_and_b32 v124, 2, v11
  v_add_u32 v11, v11, v124
  ds_write_b32 v11, v35
  v_mul_u32_u24 v124, 3, v124
  v_sub_u32 v124, v11, v124
  ds_write_b16_d16_hi v124, v103 offset:4
  v_and_b32 v117, 2, v12
  v_add_u32 v12, v12, v117
  ds_write_b32 v12, v36
  v_mul_u32_u24 v117, 3, v117
  v_sub_u32 v117, v12, v117
  ds_write_b16 v117, v104 offset:4
  v_and_b32 v118, 2, v13
  v_add_u32 v13, v13, v118
  ds_write_b32 v13, v37
  v_mul_u32_u24 v118, 3, v118
  v_sub_u32 v118, v13, v118
  ds_write_b16_d16_hi v118, v104 offset:4
  v_and_b32 v119, 2, v14
  v_add_u32 v14, v14, v119
  ds_write_b32 v14, v38
  v_mul_u32_u24 v119, 3, v119
  v_sub_u32 v119, v14, v119
  ds_write_b16 v119, v105 offset:4
  v_and_b32 v120, 2, v15
  v_add_u32 v15, v15, v120
  ds_write_b32 v15, v39
  v_mul_u32_u24 v120, 3, v120
  v_sub_u32 v120, v15, v120
  ds_write_b16_d16_hi v120, v105 offset:4
  v_and_b32 v121, 2, v16
  v_add_u32 v16, v16, v121
  ds_write_b32 v16, v40
  v_mul_u32_u24 v121, 3, v121
  v_sub_u32 v121, v16, v121
  ds_write_b16 v121, v106 offset:4
  s_add_u32 s66, s68, 81920
  buffer_load_dwordx4 v[96:99], v1, s[16:19], s66 offen nt
  v_and_b32 v122, 2, v17
  v_add_u32 v17, v17, v122
  ds_write_b32 v17, v41
  v_mul_u32_u24 v122, 3, v122
  v_sub_u32 v122, v17, v122
  ds_write_b16_d16_hi v122, v106 offset:4
  v_and_b32 v123, 2, v18
  v_add_u32 v18, v18, v123
  ds_write_b32 v18, v42
  v_mul_u32_u24 v123, 3, v123
  v_sub_u32 v123, v18, v123
  ds_write_b16 v123, v107 offset:4
  v_and_b32 v124, 2, v19
  v_add_u32 v19, v19, v124
  ds_write_b32 v19, v43
  v_mul_u32_u24 v124, 3, v124
  v_sub_u32 v124, v19, v124
  ds_write_b16_d16_hi v124, v107 offset:4
  v_and_b32 v117, 2, v20
  v_add_u32 v20, v20, v117
  ds_write_b32 v20, v44
  v_mul_u32_u24 v117, 3, v117
  v_sub_u32 v117, v20, v117
  ds_write_b16 v117, v108 offset:4
  v_and_b32 v118, 2, v21
  v_add_u32 v21, v21, v118
  ds_write_b32 v21, v45
  v_mul_u32_u24 v118, 3, v118
  v_sub_u32 v118, v21, v118
  ds_write_b16_d16_hi v118, v108 offset:4
  v_and_b32 v119, 2, v22
  v_add_u32 v22, v22, v119
  ds_write_b32 v22, v46
  v_mul_u32_u24 v119, 3, v119
  v_sub_u32 v119, v22, v119
  ds_write_b16 v119, v109 offset:4
  v_and_b32 v120, 2, v23
  v_add_u32 v23, v23, v120
  ds_write_b32 v23, v47
  v_mul_u32_u24 v120, 3, v120
  v_sub_u32 v120, v23, v120
  ds_write_b16_d16_hi v120, v109 offset:4
  v_and_b32 v121, 2, v24
  v_add_u32 v24, v24, v121
  ds_write_b32 v24, v48
  v_mul_u32_u24 v121, 3, v121
  v_sub_u32 v121, v24, v121
  ds_write_b16 v121, v110 offset:4
  v_lshrrev_b32 v126, 2, v1
  s_add_u32 s66, s68, 98304
  buffer_load_dword v115, v126, s[16:19], s66 offen nt
  v_and_b32 v122, 2, v25
  v_add_u32 v25, v25, v122
  ds_write_b32 v25, v49
  v_mul_u32_u24 v122, 3, v122
  v_sub_u32 v122, v25, v122
  ds_write_b16_d16_hi v122, v110 offset:4
  v_and_b32 v123, 2, v26
  v_add_u32 v26, v26, v123
  ds_write_b32 v26, v50
  v_mul_u32_u24 v123, 3, v123
  v_sub_u32 v123, v26, v123
  ds_write_b16 v123, v111 offset:4
  v_and_b32 v124, 2, v27
  v_add_u32 v27, v27, v124
  ds_write_b32 v27, v51
  v_mul_u32_u24 v124, 3, v124
  v_sub_u32 v124, v27, v124
  ds_write_b16_d16_hi v124, v111 offset:4
  v_and_b32 v117, 2, v112
  v_add_u32 v112, v112, v117
  ds_write_b32 v112, v113
  v_mul_u32_u24 v117, 3, v117
  v_sub_u32 v117, v112, v117
  ds_write_b16 v117, v116 offset:4
  s_waitcnt lgkmcnt(0)
  s_barrier
  s_mul_i32 s69, s65, 51200
  v_lshrrev_b32 v117, 1, v1
  v_lshrrev_b32 v118, 3, v1
  s_add_u32 s66, s69, 0
  buffer_load_dwordx2 v[100:101], v117, s[24:27], s66 offen nt
  s_add_u32 s66, s69, 8192
  buffer_load_dwordx2 v[102:103], v117, s[24:27], s66 offen nt
  s_add_u32 s66, s69, 16384
  buffer_load_dwordx2 v[104:105], v117, s[24:27], s66 offen nt
  s_add_u32 s66, s69, 24576
  buffer_load_dwordx2 v[106:107], v117, s[24:27], s66 offen nt
  s_add_u32 s66, s69, 32768
  buffer_load_dwordx2 v[108:109], v117, s[24:27], s66 offen nt
  s_add_u32 s66, s69, 40960
  buffer_load_dwordx2 v[110:111], v117, s[24:27], s66 offen nt
  s_add_u32 s66, s69, 49152
  buffer_load_ushort v116, v118, s[24:27], s66 offen nt
  v_add_u32 v119, 65536, v1
  v_add_u32 v120, 131072, v1
  ds_read_b128 v[4:7], v1 offset:0
  ds_read_b128 v[8:11], v1 offset:16384
  ds_read_b128 v[12:15], v1 offset:32768
  ds_read_b128 v[16:19], v1 offset:49152
  ds_read_b128 v[20:23], v119 offset:0
  ds_read_b128 v[24:27], v119 offset:16384
  ds_read_b128 v[28:31], v119 offset:32768
  ds_read_b128 v[32:35], v119 offset:49152
  ds_read_b128 v[36:39], v120 offset:0
  s_cmp_ge_u32 s67, 6
  s_cbranch_scc1 Lp_no100
  ds_read_b128 v[40:43], v120 offset:16384
Lp_no100:
  s_mul_i32 s75, s64, 153600
  s_mov_b32 s86, 0
  s_mov_b32 s64, s65
  s_cmp_lt_u32 s64, 1000
  s_cbranch_scc0 Lp_end0
  v_mov_b32 v117, 157696
  ds_read_b32 v117, v117
  s_waitcnt lgkmcnt(0)
  v_readfirstlane_b32 s65, v117
  s_nop 3
  s_add_u32 s65, s65, 512
Lp_body1:
  s_cmp_lt_u32 s65, 1000
  s_cselect_b32 s22, 102400000, 0
  s_cselect_b32 s18, 102400000, 0
  s_cselect_b32 s26, 51200000, 0
  s_min_u32 s66, s65, 1000
  s_mul_i32 s68, s66, 102400
  s_cmp_lg_u32 s67, 0
  s_cbranch_scc1 Lp_notk1
  s_mov_b64 exec, 1
  v_mov_b32 v3, 1
  v_mov_b32 v117, 192
  buffer_atomic_add v3, v117, s[88:91], 0 offen sc0
  s_mov_b64 exec, -1
Lp_notk1:
  v_or_b32 v127, s86, v1
  s_waitcnt lgkmcnt(0)
  s_add_u32 s66, s75, 0
  buffer_store_dwordx4 v[4:7], v127, s[28:31], s66 offen sc1
  s_add_u32 s66, s75, 16384
  buffer_store_dwordx4 v[8:11], v127, s[28:31], s66 offen sc1
  s_add_u32 s66, s75, 32768
  buffer_store_dwordx4 v[12:15], v127, s[28:31], s66 offen sc1
  s_add_u32 s66, s75, 49152
  buffer_store_dwordx4 v[16:19], v127, s[28:31], s66 offen sc1
  s_add_u32 s66, s75, 65536
  buffer_store_dwordx4 v[20:23], v127, s[28:31], s66 offen sc1
  s_add_u32 s66, s75, 81920
  buffer_store_dwordx4 v[24:27], v127, s[28:31], s66 offen sc1
  s_waitcnt vmcnt(13)
  v_mul_hi_u32_u24 v117, s71, v52
  v_mul_hi_u32_u24 v119, s73, v76
  v_mad_i32_i24 v118, v117, s72, v52
  v_lshl_add_u32 v117, v119, 8, v117
  v_lshl_or_b32 v76, v118, 20, v76
  v_lshl_add_u32 v52, v117, 2, s74
  ds_add_u32 v52, v2
  s_add_u32 s66, s75, 98304
  buffer_store_dwordx4 v[28:31], v127, s[28:31], s66 offen sc1
  v_mul_hi_u32_u24 v120, s71, v53
  v_mul_hi_u32_u24 v122, s73, v77
  v_mad_i32_i24 v121, v120, s72, v53
  v_lshl_add_u32 v120, v122, 8, v120
  v_lshl_or_b32 v77, v121, 20, v77
  v_lshl_add_u32 v53, v120, 2, s74
  ds_add_u32 v53, v2
  s_add_u32 s66, s75, 114688
  buffer_store_dwordx4 v[32:35], v127, s[28:31], s66 offen sc1
  v_mul_hi_u32_u24 v123, s71, v54
  v_mul_hi_u32_u24 v125, s73, v78
  v_mad_i32_i24 v124, v123, s72, v54
  v_lshl_add_u32 v123, v125, 8, v123
  v_lshl_or_b32 v78, v124, 20, v78
  v_lshl_add_u32 v54, v123, 2, s74
  ds_add_u32 v54, v2
  s_add_u32 s66, s75, 131072
  buffer_store_dwordx4 v[36:39], v127, s[28:31], s66 offen sc1
  v_mul_hi_u32_u24 v117, s71, v55
  v_mul_hi_u32_u24 v119, s73, v79
  v_mad_i32_i24 v118, v117, s72, v55
  v_lshl_add_u32 v117, v119, 8, v117
  v_lshl_or_b32 v79, v118, 20, v79
  v_lshl_add_u32 v55, v117, 2, s74
  ds_add_u32 v55, v2
  s_add_u32 s66, s75, 147456
  v_or_b32 v126, s87, v127
  buffer_store_dwordx4 v[40:43], v126, s[28:31], s66 offen sc1
  v_mul_hi_u32_u24 v120, s71, v56
  v_mul_hi_u32_u24 v122, s73, v80
  v_mad_i32_i24 v121, v120, s72, v56
  v_lshl_add_u32 v120, v122, 8, v120
  v_lshl_or_b32 v80, v121, 20, v80
  v_lshl_add_u32 v56, v120, 2, s74
  ds_add_u32 v56, v2
  v_mul_hi_u32_u24 v123, s71, v57
  v_mul_hi_u32_u24 v125, s73, v81
  v_mad_i32_i24 v124, v123, s72, v57
  v_lshl_add_u32 v123, v125, 8, v123
  v_lshl_or_b32 v81, v124, 20, v81
  v_lshl_add_u32 v57, v123, 2, s74
  ds_add_u32 v57, v2
  s_add_u32 s66, s68, 0
  buffer_load_dwordx4 v[4:7], v1, s[20:23], s66 offen nt
  v_mul_hi_u32_u24 v117, s71, v58
  v_mul_hi_u32_u24 v119, s73, v82
  v_mad_i32_i24 v118, v117, s72, v58
  v_lshl_add_u32 v117, v119, 8, v117
  v_lshl_or_b32 v82, v118, 20, v82
  v_lshl_add_u32 v58, v117, 2, s74
  ds_add_u32 v58, v2
  v_mul_hi_u32_u24 v120, s71, v59
  v_mul_hi_u32_u24 v122, s73, v83
  v_mad_i32_i24 v121, v120, s72, v59
  v_lshl_add_u32 v120, v122, 8, v120
  v_lshl_or_b32 v83, v121, 20, v83
  v_lshl_add_u32 v59, v120, 2, s74
  ds_add_u32 v59, v2
  v_mul_hi_u32_u24 v123, s71, v60
  v_mul_hi_u32_u24 v125, s73, v84
  v_mad_i32_i24 v124, v123, s72, v60
  v_lshl_add_u32 v123, v125, 8, v123
  v_lshl_or_b32 v84, v124, 20, v84
  v_lshl_add_u32 v60, v123, 2, s74
  ds_add_u32 v60, v2
  s_add_u32 s66, s68, 16384
  buffer_load_dwordx4 v[8:11], v1, s[20:23], s66 offen nt
  v_mul_hi_u32_u24 v117, s71, v61
  v_mul_hi_u32_u24 v119, s73, v85
  v_mad_i32_i24 v118, v117, s72, v61
  v_lshl_add_u32 v117, v119, 8, v117
  v_lshl_or_b32 v85, v118, 20, v85
  v_lshl_add_u32 v61, v117, 2, s74
  ds_add_u32 v61, v2
  v_mul_hi_u32_u24 v120, s71, v62
  v_mul_hi_u32_u24 v122, s73, v86
  v_mad_i32_i24 v121, v120, s72, v62
  v_lshl_add_u32 v120, v122, 8, v120
  v_lshl_or_b32 v86, v121, 20, v86
  v_lshl_add_u32 v62, v120, 2, s74
  ds_add_u32 v62, v2
  v_mul_hi_u32_u24 v123, s71, v63
  v_mul_hi_u32_u24 v125, s73, v87
  v_mad_i32_i24 v124, v123, s72, v63
  v_lshl_add_u32 v123, v125, 8, v123
  v_lshl_or_b32 v87, v124, 20, v87
  v_lshl_add_u32 v63, v123, 2, s74
  ds_add_u32 v63, v2
  s_add_u32 s66, s68, 32768
  buffer_load_dwordx4 v[12:15], v1, s[20:23], s66 offen nt
  v_mul_hi_u32_u24 v117, s71, v64
  v_mul_hi_u32_u24 v119, s73, v88
  v_mad_i32_i24 v118, v117, s72, v64
  v_lshl_add_u32 v117, v119, 8, v117
  v_lshl_or_b32 v88, v118, 20, v88
  v_lshl_add_u32 v64, v117, 2, s74
  ds_add_u32 v64, v2
  v_mul_hi_u32_u24 v120, s71, v65
  v_mul_hi_u32_u24 v122, s73, v89
  v_mad_i32_i24 v121, v120, s72, v65
  v_lshl_add_u32 v120, v122, 8, v120
  v_lshl_or_b32 v89, v121, 20, v89
  v_lshl_add_u32 v65, v120, 2, s74
  ds_add_u32 v65, v2
  v_mul_hi_u32_u24 v123, s71, v66
  v_mul_hi_u32_u24 v125, s73, v90
  v_mad_i32_i24 v124, v123, s72, v66
  v_lshl_add_u32 v123, v125, 8, v123
  v_lshl_or_b32 v90, v124, 20, v90
  v_lshl_add_u32 v66, v123, 2, s74
  ds_add_u32 v66, v2
  s_add_u32 s66, s68, 49152
  buffer_load_dwordx4 v[16:19], v1, s[20:23], s66 offen nt
  v_mul_hi_u32_u24 v117, s71, v67
  v_mul_hi_u32_u24 v119, s73, v91
  v_mad_i32_i24 v118, v117, s72, v67
  v_lshl_add_u32 v117, v119, 8, v117
  v_lshl_or_b32 v91, v118, 20, v91
  v_lshl_add_u32 v67, v117, 2, s74
  ds_add_u32 v67, v2
  v_mul_hi_u32_u24 v120, s71, v68
  v_mul_hi_u32_u24 v122, s73, v92
  v_mad_i32_i24 v121, v120, s72, v68
  v_lshl_add_u32 v120, v122, 8, v120
  v_lshl_or_b32 v92, v121, 20, v92
  v_lshl_add_u32 v68, v120, 2, s74
  ds_add_u32 v68, v2
  v_mul_hi_u32_u24 v123, s71, v69
  v_mul_hi_u32_u24 v125, s73, v93
  v_mad_i32_i24 v124, v123, s72, v69
  v_lshl_add_u32 v123, v125, 8, v123
  v_lshl_or_b32 v93, v124, 20, v93
  v_lshl_add_u32 v69, v123, 2, s74
  ds_add_u32 v69, v2
  s_add_u32 s66, s68, 65536
  buffer_load_dwordx4 v[20:23], v1, s[20:23], s66 offen nt
  v_mul_hi_u32_u24 v117, s71, v70
  v_mul_hi_u32_u24 v119, s73, v94
  v_mad_i32_i24 v118, v117, s72, v70
  v_lshl_add_u32 v117, v119, 8, v117
  v_lshl_or_b32 v94, v118, 20, v94
  v_lshl_add_u32 v70, v117, 2, s74
  ds_add_u32 v70, v2
  v_mul_hi_u32_u24 v120, s71, v71
  v_mul_hi_u32_u24 v122, s73, v95
  v_mad_i32_i24 v121, v120, s72, v71
  v_lshl_add_u32 v120, v122, 8, v120
  v_lshl_or_b32 v95, v121, 20, v95
  v_lshl_add_u32 v71, v120, 2, s74
  ds_add_u32 v71, v2
  v_mul_hi_u32_u24 v123, s71, v72
  v_mul_hi_u32_u24 v125, s73, v96
  v_mad_i32_i24 v124, v123, s72, v72
  v_lshl_add_u32 v123, v125, 8, v123
  v_lshl_or_b32 v96, v124, 20, v96
  v_lshl_add_u32 v72, v123, 2, s74
  ds_add_u32 v72, v2
  s_add_u32 s66, s68, 81920
  buffer_load_dwordx4 v[24:27], v1, s[20:23], s66 offen nt
  v_mul_hi_u32_u24 v117, s71, v73
  v_mul_hi_u32_u24 v119, s73, v97
  v_mad_i32_i24 v118, v117, s72, v73
  v_lshl_add_u32 v117, v119, 8, v117
  v_lshl_or_b32 v97, v118, 20, v97
  v_lshl_add_u32 v73, v117, 2, s74
  ds_add_u32 v73, v2
  v_mul_hi_u32_u24 v120, s71, v74
  v_mul_hi_u32_u24 v122, s73, v98
  v_mad_i32_i24 v121, v120, s72, v74
  v_lshl_add_u32 v120, v122, 8, v120
  v_lshl_or_b32 v98, v121, 20, v98
  v_lshl_add_u32 v74, v120, 2, s74
  ds_add_u32 v74, v2
  v_mul_hi_u32_u24 v123, s71, v75
  v_mul_hi_u32_u24 v125, s73, v99
  v_mad_i32_i24 v124, v123, s72, v75
  v_lshl_add_u32 v123, v125, 8, v123
  v_lshl_or_b32 v99, v124, 20, v99
  v_lshl_add_u32 v75, v123, 2, s74
  ds_add_u32 v75, v2
  v_lshrrev_b32 v126, 2, v1
  s_add_u32 s66, s68, 98304
  buffer_load_dword v112, v126, s[20:23], s66 offen nt
  v_mul_hi_u32_u24 v117, s71, v114
  v_mul_hi_u32_u24 v119, s73, v115
  v_mad_i32_i24 v118, v117, s72, v114
  v_lshl_add_u32 v117, v119, 8, v117
  v_lshl_or_b32 v115, v118, 20, v115
  v_lshl_add_u32 v114, v117, 2, s74
  ds_add_u32 v114, v2
  s_waitcnt lgkmcnt(0)
  s_barrier
  s_cmp_lg_u32 s67, 0
  s_cbranch_scc1 Lp_noscan1
  s_waitcnt vmcnt(17)
  v_mov_b32 v117, 157696
  s_mov_b64 exec, 1
  ds_write_b32 v117, v3
  s_mov_b64 exec, -1
  v_lshlrev_b32 v3, 5, v0
  v_add_u32 v3, 153600, v3
  ds_read_b128 v[120:123], v3
  ds_read_b128 v[124:127], v3 offset:16
  v_mov_b32 v118, 0
  v_mov_b32 v119, 0
  s_waitcnt lgkmcnt(0)
  ds_write_b64 v3, v[118:119] offset:0
  ds_write_b64 v3, v[118:119] offset:8
  ds_write_b64 v3, v[118:119] offset:16
  ds_write_b64 v3, v[118:119] offset:24
  v_add_u32 v121, v121, v120
  v_add_u32 v122, v122, v121
  v_add_u32 v123, v123, v122
  v_add_u32 v124, v124, v123
  v_add_u32 v125, v125, v124
  v_add_u32 v126, v126, v125
  v_add_u32 v127, v127, v126
  v_mov_b32 v117, v127
  s_nop 1
  v_add_u32_dpp v117, v117, v117 row_shr:1 row_mask:0xf bank_mask:0xf
  s_nop 1
  v_add_u32_dpp v117, v117, v117 row_shr:2 row_mask:0xf bank_mask:0xf
  s_nop 1
  v_add_u32_dpp v117, v117, v117 row_shr:4 row_mask:0xf bank_mask:0xf
  s_nop 1
  v_add_u32_dpp v117, v117, v117 row_shr:8 row_mask:0xf bank_mask:0xf
  s_nop 1
  v_add_u32_dpp v117, v117, v117 row_bcast:15 row_mask:0xa bank_mask:0xf
  s_nop 1
  v_add_u32_dpp v117, v117, v117 row_bcast:31 row_mask:0xc bank_mask:0xf
  s_waitcnt lgkmcnt(0)
  v_sub_u32 v118, v117, v127
  v_add_u32 v127, v118, v126
  v_add_u32 v126, v118, v125
  v_add_u32 v125, v118, v124
  v_add_u32 v124, v118, v123
  v_add_u32 v123, v118, v122
  v_add_u32 v122, v118, v121
  v_add_u32 v121, v118, v120
  v_mov_b32 v120, v118
  ds_write_b128 v3, v[120:123] offset:2048
  ds_write_b128 v3, v[124:127] offset:2064
  s_waitcnt lgkmcnt(0)
  v_lshrrev_b32 v120, 1, v120
  v_mul_u32_u24 v120, 43691, v120
  v_lshrrev_b32 v120, 17, v120
  v_lshrrev_b32 v121, 1, v121
  v_mul_u32_u24 v121, 43691, v121
  v_lshrrev_b32 v121, 17, v121
  v_lshrrev_b32 v122, 1, v122
  v_mul_u32_u24 v122, 43691, v122
  v_lshrrev_b32 v122, 17, v122
  v_lshrrev_b32 v123, 1, v123
  v_mul_u32_u24 v123, 43691, v123
  v_lshrrev_b32 v123, 17, v123
  v_lshrrev_b32 v124, 1, v124
  v_mul_u32_u24 v124, 43691, v124
  v_lshrrev_b32 v124, 17, v124
  v_lshrrev_b32 v125, 1, v125
  v_mul_u32_u24 v125, 43691, v125
  v_lshrrev_b32 v125, 17, v125
  v_lshrrev_b32 v126, 1, v126
  v_mul_u32_u24 v126, 43691, v126
  v_lshrrev_b32 v126, 17, v126
  v_lshrrev_b32 v127, 1, v127
  v_mul_u32_u24 v127, 43691, v127
  v_lshrrev_b32 v127, 17, v127
  v_lshrrev_b32 v117, 1, v117
  v_mul_u32_u24 v117, 43691, v117
  v_lshrrev_b32 v117, 17, v117
  v_sub_u32 v118, v121, v120
  v_lshl_or_b32 v120, v118, 16, v120
  v_sub_u32 v118, v122, v121
  v_lshl_or_b32 v121, v118, 16, v121
  v_sub_u32 v118, v123, v122
  v_lshl_or_b32 v122, v118, 16, v122
  v_sub_u32 v118, v124, v123
  v_lshl_or_b32 v123, v118, 16, v123
  v_sub_u32 v118, v125, v124
  v_lshl_or_b32 v124, v118, 16, v124
  v_sub_u32 v118, v126, v125
  v_lshl_or_b32 v125, v118, 16, v125
  v_sub_u32 v118, v127, v126
  v_lshl_or_b32 v126, v118, 16, v126
  v_sub_u32 v118, v117, v127
  v_lshl_or_b32 v127, v118, 16, v127
  s_mul_i32 s70, s64, 2048
  s_add_u32 s70, s70, 153600000
  v_lshl_add_u32 v117, v1, 1, s70
  buffer_store_dwordx4 v[120:123], v117, s[28:31], 0 offen sc1
  buffer_store_dwordx4 v[124:127], v117, s[28:31], 0 offen offset:16 sc1
Lp_noscan1:
  s_barrier
  ds_add_rtn_u32 v52, v52, v2 offset:2048
  ds_add_rtn_u32 v53, v53, v2 offset:2048
  ds_add_rtn_u32 v54, v54, v2 offset:2048
  ds_add_rtn_u32 v55, v55, v2 offset:2048
  s_add_u32 s66, s68, 0
  buffer_load_dwordx4 v[28:31], v1, s[16:19], s66 offen nt
  ds_add_rtn_u32 v56, v56, v2 offset:2048
  ds_add_rtn_u32 v57, v57, v2 offset:2048
  ds_add_rtn_u32 v58, v58, v2 offset:2048
  ds_add_rtn_u32 v59, v59, v2 offset:2048
  ds_add_rtn_u32 v60, v60, v2 offset:2048
  ds_add_rtn_u32 v61, v61, v2 offset:2048
  s_add_u32 s66, s68, 16384
  buffer_load_dwordx4 v[32:35], v1, s[16:19], s66 offen nt
  ds_add_rtn_u32 v62, v62, v2 offset:2048
  ds_add_rtn_u32 v63, v63, v2 offset:2048
  ds_add_rtn_u32 v64, v64, v2 offset:2048
  ds_add_rtn_u32 v65, v65, v2 offset:2048
  ds_add_rtn_u32 v66, v66, v2 offset:2048
  ds_add_rtn_u32 v67, v67, v2 offset:2048
  s_add_u32 s66, s68, 32768
  buffer_load_dwordx4 v[36:39], v1, s[16:19], s66 offen nt
  ds_add_rtn_u32 v68, v68, v2 offset:2048
  ds_add_rtn_u32 v69, v69, v2 offset:2048
  ds_add_rtn_u32 v70, v70, v2 offset:2048
  ds_add_rtn_u32 v71, v71, v2 offset:2048
  ds_add_rtn_u32 v72, v72, v2 offset:2048
  ds_add_rtn_u32 v73, v73, v2 offset:2048
  s_add_u32 s66, s68, 49152
  buffer_load_dwordx4 v[40:43], v1, s[16:19], s66 offen nt
  ds_add_rtn_u32 v74, v74, v2 offset:2048
  ds_add_rtn_u32 v75, v75, v2 offset:2048
  ds_add_rtn_u32 v114, v114, v2 offset:2048
  s_waitcnt vmcnt(21) lgkmcnt(0)
  v_and_b32 v117, 2, v52
  v_add_u32 v52, v52, v117
  ds_write_b32 v52, v76
  v_mul_u32_u24 v117, 3, v117
  v_sub_u32 v117, v52, v117
  ds_write_b16 v117, v100 offset:4
  v_and_b32 v118, 2, v53
  v_add_u32 v53, v53, v118
  ds_write_b32 v53, v77
  v_mul_u32_u24 v118, 3, v118
  v_sub_u32 v118, v53, v118
  ds_write_b16_d16_hi v118, v100 offset:4
  v_and_b32 v119, 2, v54
  v_add_u32 v54, v54, v119
  ds_write_b32 v54, v78
  v_mul_u32_u24 v119, 3, v119
  v_sub_u32 v119, v54, v119
  ds_write_b16 v119, v101 offset:4
  v_and_b32 v120, 2, v55
  v_add_u32 v55, v55, v120
  ds_write_b32 v55, v79
  v_mul_u32_u24 v120, 3, v120
  v_sub_u32 v120, v55, v120
  ds_write_b16_d16_hi v120, v101 offset:4
  v_and_b32 v121, 2, v56
  v_add_u32 v56, v56, v121
  ds_write_b32 v56, v80
  v_mul_u32_u24 v121, 3, v121
  v_sub_u32 v121, v56, v121
  ds_write_b16 v121, v102 offset:4
  s_add_u32 s66, s68, 65536
  buffer_load_dwordx4 v[44:47], v1, s[16:19], s66 offen nt
  v_and_b32 v122, 2, v57
  v_add_u32 v57, v57, v122
  ds_write_b32 v57, v81
  v_mul_u32_u24 v122, 3, v122
  v_sub_u32 v122, v57, v122
  ds_write_b16_d16_hi v122, v102 offset:4
  v_and_b32 v123, 2, v58
  v_add_u32 v58, v58, v123
  ds_write_b32 v58, v82
  v_mul_u32_u24 v123, 3, v123
  v_sub_u32 v123, v58, v123
  ds_write_b16 v123, v103 offset:4
  v_and_b32 v124, 2, v59
  v_add_u32 v59, v59, v124
  ds_write_b32 v59, v83
  v_mul_u32_u24 v124, 3, v124
  v_sub_u32 v124, v59, v124
  ds_write_b16_d16_hi v124, v103 offset:4
  v_and_b32 v117, 2, v60
  v_add_u32 v60, v60, v117
  ds_write_b32 v60, v84
  v_mul_u32_u24 v117, 3, v117
  v_sub_u32 v117, v60, v117
  ds_write_b16 v117, v104 offset:4
  v_and_b32 v118, 2, v61
  v_add_u32 v61, v61, v118
  ds_write_b32 v61, v85
  v_mul_u32_u24 v118, 3, v118
  v_sub_u32 v118, v61, v118
  ds_write_b16_d16_hi v118, v104 offset:4
  v_and_b32 v119, 2, v62
  v_add_u32 v62, v62, v119
  ds_write_b32 v62, v86
  v_mul_u32_u24 v119, 3, v119
  v_sub_u32 v119, v62, v119
  ds_write_b16 v119, v105 offset:4
  v_and_b32 v120, 2, v63
  v_add_u32 v63, v63, v120
  ds_write_b32 v63, v87
  v_mul_u32_u24 v120, 3, v120
  v_sub_u32 v120, v63, v120
  ds_write_b16_d16_hi v120, v105 offset:4
  v_and_b32 v121, 2, v64
  v_add_u32 v64, v64, v121
  ds_write_b32 v64, v88
  v_mul_u32_u24 v121, 3, v121
  v_sub_u32 v121, v64, v121
  ds_write_b16 v121, v106 offset:4
  s_add_u32 s66, s68, 81920
  buffer_load_dwordx4 v[48:51], v1, s[16:19], s66 offen nt
  v_and_b32 v122, 2, v65
  v_add_u32 v65, v65, v122
  ds_write_b32 v65, v89
  v_mul_u32_u24 v122, 3, v122
  v_sub_u32 v122, v65, v122
  ds_write_b16_d16_hi v122, v106 offset:4
  v_and_b32 v123, 2, v66
  v_add_u32 v66, v66, v123
  ds_write_b32 v66, v90
  v_mul_u32_u24 v123, 3, v123
  v_sub_u32 v123, v66, v123
  ds_write_b16 v123, v107 offset:4
  v_and_b32 v124, 2, v67
  v_add_u32 v67, v67, v124
  ds_write_b32 v67, v91
  v_mul_u32_u24 v124, 3, v124
  v_sub_u32 v124, v67, v124
  ds_write_b16_d16_hi v124, v107 offset:4
  v_and_b32 v117, 2, v68
  v_add_u32 v68, v68, v117
  ds_write_b32 v68, v92
  v_mul_u32_u24 v117, 3, v117
  v_sub_u32 v117, v68, v117
  ds_write_b16 v117, v108 offset:4
  v_and_b32 v118, 2, v69
  v_add_u32 v69, v69, v118
  ds_write_b32 v69, v93
  v_mul_u32_u24 v118, 3, v118
  v_sub_u32 v118, v69, v118
  ds_write_b16_d16_hi v118, v108 offset:4
  v_and_b32 v119, 2, v70
  v_add_u32 v70, v70, v119
  ds_write_b32 v70, v94
  v_mul_u32_u24 v119, 3, v119
  v_sub_u32 v119, v70, v119
  ds_write_b16 v119, v109 offset:4
  v_and_b32 v120, 2, v71
  v_add_u32 v71, v71, v120
  ds_write_b32 v71, v95
  v_mul_u32_u24 v120, 3, v120
  v_sub_u32 v120, v71, v120
  ds_write_b16_d16_hi v120, v109 offset:4
  v_and_b32 v121, 2, v72
  v_add_u32 v72, v72, v121
  ds_write_b32 v72, v96
  v_mul_u32_u24 v121, 3, v121
  v_sub_u32 v121, v72, v121
  ds_write_b16 v121, v110 offset:4
  v_lshrrev_b32 v126, 2, v1
  s_add_u32 s66, s68, 98304
  buffer_load_dword v113, v126, s[16:19], s66 offen nt
  v_and_b32 v122, 2, v73
  v_add_u32 v73, v73, v122
  ds_write_b32 v73, v97
  v_mul_u32_u24 v122, 3, v122
  v_sub_u32 v122, v73, v122
  ds_write_b16_d16_hi v122, v110 offset:4
  v_and_b32 v123, 2, v74
  v_add_u32 v74, v74, v123
  ds_write_b32 v74, v98
  v_mul_u32_u24 v123, 3, v123
  v_sub_u32 v123, v74, v123
  ds_write_b16 v123, v111 offset:4
  v_and_b32 v124, 2, v75
  v_add_u32 v75, v75, v124
  ds_write_b32 v75, v99
  v_mul_u32_u24 v124, 3, v124
  v_sub_u32 v124, v75, v124
  ds_write_b16_d16_hi v124, v111 offset:4
  v_and_b32 v117, 2, v114
  v_add_u32 v114, v114, v117
  ds_write_b32 v114, v115
  v_mul_u32_u24 v117, 3, v117
  v_sub_u32 v117, v114, v117
  ds_write_b16 v117, v116 offset:4
  s_waitcnt lgkmcnt(0)
  s_barrier
  s_mul_i32 s69, s65, 51200
  v_lshrrev_b32 v117, 1, v1
  v_lshrrev_b32 v118, 3, v1
  s_add_u32 s66, s69, 0
  buffer_load_dwordx2 v[100:101], v117, s[24:27], s66 offen nt
  s_add_u32 s66, s69, 8192
  buffer_load_dwordx2 v[102:103], v117, s[24:27], s66 offen nt
  s_add_u32 s66, s69, 16384
  buffer_load_dwordx2 v[104:105], v117, s[24:27], s66 offen nt
  s_add_u32 s66, s69, 24576
  buffer_load_dwordx2 v[106:107], v117, s[24:27], s66 offen nt
  s_add_u32 s66, s69, 32768
  buffer_load_dwordx2 v[108:109], v117, s[24:27], s66 offen nt
  s_add_u32 s66, s69, 40960
  buffer_load_dwordx2 v[110:111], v117, s[24:27], s66 offen nt
  s_add_u32 s66, s69, 49152
  buffer_load_ushort v116, v118, s[24:27], s66 offen nt
  v_add_u32 v119, 65536, v1
  v_add_u32 v120, 131072, v1
  ds_read_b128 v[52:55], v1 offset:0
  ds_read_b128 v[56:59], v1 offset:16384
  ds_read_b128 v[60:63], v1 offset:32768
  ds_read_b128 v[64:67], v1 offset:49152
  ds_read_b128 v[68:71], v119 offset:0
  ds_read_b128 v[72:75], v119 offset:16384
  ds_read_b128 v[76:79], v119 offset:32768
  ds_read_b128 v[80:83], v119 offset:49152
  ds_read_b128 v[84:87], v120 offset:0
  s_cmp_ge_u32 s67, 6
  s_cbranch_scc1 Lp_no101
  ds_read_b128 v[88:91], v120 offset:16384
Lp_no101:
  s_mul_i32 s75, s64, 153600
  s_mov_b32 s86, 0
  s_mov_b32 s64, s65
  s_cmp_lt_u32 s64, 1000
  s_cbranch_scc0 Lp_end1
  v_mov_b32 v117, 157696
  ds_read_b32 v117, v117
  s_waitcnt lgkmcnt(0)
  v_readfirstlane_b32 s65, v117
  s_nop 3
  s_add_u32 s65, s65, 512
  s_branch Lp_body0
Lp_end0:
  v_mov_b32 v127, v1
  s_waitcnt lgkmcnt(0)
  s_add_u32 s66, s75, 0
  buffer_store_dwordx4 v[4:7], v127, s[28:31], s66 offen sc1
  s_add_u32 s66, s75, 16384
  buffer_store_dwordx4 v[8:11], v127, s[28:31], s66 offen sc1
  s_add_u32 s66, s75, 32768
  buffer_store_dwordx4 v[12:15], v127, s[28:31], s66 offen sc1
  s_add_u32 s66, s75, 49152
  buffer_store_dwordx4 v[16:19], v127, s[28:31], s66 offen sc1
  s_add_u32 s66, s75, 65536
  buffer_store_dwordx4 v[20:23], v127, s[28:31], s66 offen sc1
  s_add_u32 s66, s75, 81920
  buffer_store_dwordx4 v[24:27], v127, s[28:31], s66 offen sc1
  s_add_u32 s66, s75, 98304
  buffer_store_dwordx4 v[28:31], v127, s[28:31], s66 offen sc1
  s_add_u32 s66, s75, 114688
  buffer_store_dwordx4 v[32:35], v127, s[28:31], s66 offen sc1
  s_add_u32 s66, s75, 131072
  buffer_store_dwordx4 v[36:39], v127, s[28:31], s66 offen sc1
  s_add_u32 s66, s75, 147456
  v_or_b32 v126, s87, v127
  buffer_store_dwordx4 v[40:43], v126, s[28:31], s66 offen sc1
  s_endpgm
Lp_end1:
  v_mov_b32 v127, v1
  s_waitcnt lgkmcnt(0)
  s_add_u32 s66, s75, 0
  buffer_store_dwordx4 v[52:55], v127, s[28:31], s66 offen sc1
  s_add_u32 s66, s75, 16384
  buffer_store_dwordx4 v[56:59], v127, s[28:31], s66 offen sc1
  s_add_u32 s66, s75, 32768
  buffer_store_dwordx4 v[60:63], v127, s[28:31], s66 offen sc1
  s_add_u32 s66, s75, 49152
  buffer_store_dwordx4 v[64:67], v127, s[28:31], s66 offen sc1
  s_add_u32 s66, s75, 65536
  buffer_store_dwordx4 v[68:71], v127, s[28:31], s66 offen sc1
  s_add_u32 s66, s75, 81920
  buffer_store_dwordx4 v[72:75], v127, s[28:31], s66 offen sc1
  s_add_u32 s66, s75, 98304
  buffer_store_dwordx4 v[76:79], v127, s[28:31], s66 offen sc1
  s_add_u32 s66, s75, 114688
  buffer_store_dwordx4 v[80:83], v127, s[28:31], s66 offen sc1
  s_add_u32 s66, s75, 131072
  buffer_store_dwordx4 v[84:87], v127, s[28:31], s66 offen sc1
  s_add_u32 s66, s75, 147456
  v_or_b32 v126, s87, v127
  buffer_store_dwordx4 v[88:91], v126, s[28:31], s66 offen sc1
  s_endpgm
Lp_exit:
  s_endpgm
.globl cons_kernel
.p2align 8
.type cons_kernel,@function
cons_kernel:
  s_cmp_ge_u32 s2, 256
  s_cbranch_scc1 Lc_exit
  s_and_b32 s4, s2, 7
  s_lshr_b32 s2, s2, 3
  s_lshl_b32 s4, s4, 5
  s_add_u32 s2, s2, s4
  s_load_dwordx4 s[12:15], s[0:1], 24
  s_load_dwordx8 s[16:23], s[0:1], 40
  s_load_dwordx2 s[24:25], s[0:1], 104
  v_and_b32 v7, 63, v0
  v_add_u32 v72, 0, v7
  v_lshrrev_b32 v73, 1, v72
  v_and_b32 v72, 1, v72
  v_mul_u32_u24 v73, 12, v73
  v_lshl_add_u32 v1, v72, 2, v73
  v_add_u32 v72, 1, v7
  v_lshrrev_b32 v73, 1, v72
  v_and_b32 v72, 1, v72
  v_mul_u32_u24 v73, 12, v73
  v_lshl_add_u32 v124, v72, 2, v73
  v_lshlrev_b32 v126, 2, v7
  v_readfirstlane_b32 s3, v0
  s_waitcnt lgkmcnt(0)
  s_lshr_b32 s3, s3, 6
  s_load_dwordx16 s[28:43], s[22:23], 0
  s_load_dwordx16 s[44:59], s[22:23], 64
  s_load_dwordx4 s[92:95], s[16:17], 0
  s_load_dword s100, s[18:19], 0
  s_mov_b32 s4, s24
  s_and_b32 s5, s25, 0xffff
  s_mov_b32 s6, 155648000
  s_mov_b32 s7, 0x00020000
  s_mov_b32 s8, s12
  s_and_b32 s9, s13, 0xffff
  s_mov_b32 s10, 1600000
  s_mov_b32 s11, 0x00020000
  s_load_dwordx16 s[12:27], s[20:21], 0
  s_mul_i32 s96, s2, 6250
  v_lshlrev_b32 v77, 1, v0
  v_add_u32 v77, s96, v77
  v_add_u32 v76, 4096, v77
  buffer_load_ushort v80, v77, s[8:11], 0 offen offset:0
  buffer_load_ushort v81, v77, s[8:11], 0 offen offset:2048
  buffer_load_ushort v82, v76, s[8:11], 0 offen offset:0
  buffer_load_ushort v83, v76, s[8:11], 0 offen offset:2048
  s_lshl_b32 s97, s2, 2
  s_add_u32 s96, s97, 153600000
  v_mul_u32_u24 v76, 2048, v0
  v_add_u32 v76, s96, v76
  buffer_load_dword v3, v76, s[4:7], 0 offen
  buffer_load_dword v4, v76, s[4:7], 0 offen offset:1024
  v_mov_b32 v84, 0
  v_mov_b32 v85, 0
  v_mov_b32 v86, 0
  v_mov_b32 v87, 0
  v_lshlrev_b32 v88, 4, v0
  v_add_u32 v88, 50000, v88
  v_add_u32 v89, 65536, v88
  ds_write_b128 v88, v[84:87] offset:0
  ds_write_b128 v88, v[84:87] offset:16384
  ds_write_b128 v88, v[84:87] offset:32768
  ds_write_b128 v88, v[84:87] offset:49152
  ds_write_b128 v89, v[84:87] offset:0
  ds_write_b128 v89, v[84:87] offset:16384
  v_cmp_gt_u32 vcc, 106, v0
  s_and_saveexec_b64 s[96:97], vcc
  s_cbranch_execz Lc_z
  ds_write_b128 v89, v[84:87] offset:32768
Lc_z:
  s_mov_b64 exec, s[96:97]
  v_mov_b32 v25, 0
  v_mov_b32 v27, 0
  v_mov_b32 v29, 0
  v_mov_b32 v31, 0
  s_waitcnt lgkmcnt(0)
  s_pack_ll_b32_b16 s60, s28, s32
  s_pack_ll_b32_b16 s61, s36, s40
  s_pack_ll_b32_b16 s62, s44, s48
  s_pack_ll_b32_b16 s63, s52, s56
  s_pack_hh_b32_b16 s64, s28, s32
  s_pack_hh_b32_b16 s65, s36, s40
  s_pack_hh_b32_b16 s66, s44, s48
  s_pack_hh_b32_b16 s67, s52, s56
  s_pack_ll_b32_b16 s68, s29, s33
  s_pack_ll_b32_b16 s69, s37, s41
  s_pack_ll_b32_b16 s70, s45, s49
  s_pack_ll_b32_b16 s71, s53, s57
  s_pack_hh_b32_b16 s72, s29, s33
  s_pack_hh_b32_b16 s73, s37, s41
  s_pack_hh_b32_b16 s74, s45, s49
  s_pack_hh_b32_b16 s75, s53, s57
  s_pack_ll_b32_b16 s76, s30, s34
  s_pack_ll_b32_b16 s77, s38, s42
  s_pack_ll_b32_b16 s78, s46, s50
  s_pack_ll_b32_b16 s79, s54, s58
  s_pack_hh_b32_b16 s80, s30, s34
  s_pack_hh_b32_b16 s81, s38, s42
  s_pack_hh_b32_b16 s82, s46, s50
  s_pack_hh_b32_b16 s83, s54, s58
  s_pack_ll_b32_b16 s84, s31, s35
  s_pack_ll_b32_b16 s85, s39, s43
  s_pack_ll_b32_b16 s86, s47, s51
  s_pack_ll_b32_b16 s87, s55, s59
  s_pack_hh_b32_b16 s88, s31, s35
  s_pack_hh_b32_b16 s89, s39, s43
  s_pack_hh_b32_b16 s90, s47, s51
  s_pack_hh_b32_b16 s91, s55, s59
  s_pack_ll_b32_b16 s28, s12, s14
  s_pack_ll_b32_b16 s29, s16, s18
  s_pack_ll_b32_b16 s30, s20, s22
  s_pack_ll_b32_b16 s31, s24, s26
  s_pack_hh_b32_b16 s32, s12, s14
  s_pack_hh_b32_b16 s33, s16, s18
  s_pack_hh_b32_b16 s34, s20, s22
  s_pack_hh_b32_b16 s35, s24, s26
  s_pack_ll_b32_b16 s36, s13, s15
  s_pack_ll_b32_b16 s37, s17, s19
  s_pack_ll_b32_b16 s38, s21, s23
  s_pack_ll_b32_b16 s39, s25, s27
  s_pack_hh_b32_b16 s40, s13, s15
  s_pack_hh_b32_b16 s41, s17, s19
  s_pack_hh_b32_b16 s42, s21, s23
  s_pack_hh_b32_b16 s43, s25, s27
  s_and_b32 s99, s95, 0xffff0000
  s_lshl_b32 s98, s95, 16
  s_and_b32 s97, s94, 0xffff0000
  s_lshl_b32 s96, s94, 16
  s_and_b32 s95, s93, 0xffff0000
  s_lshl_b32 s94, s93, 16
  s_and_b32 s93, s92, 0xffff0000
  s_lshl_b32 s92, s92, 16
  s_lshl_b32 s44, s100, 16
  s_and_b32 s45, s100, 0xffff0000
  v_mov_b32 v5, s44
  v_mov_b32 v6, s45
  v_mul_f32 v5, 0.15915494, v5
  v_mul_f32 v6, 0.15915494, v6
  s_mov_b32 s46, 0xc166d4ca
  s_load_dwordx2 s[48:49], s[0:1], 0
  s_load_dwordx4 s[52:55], s[0:1], 80
  s_waitcnt vmcnt(2)
  v_lshlrev_b32 v80, 16, v80
  v_subrev_f32 v92, s92, v80
  v_subrev_f32 v93, s93, v80
  v_subrev_f32 v94, s94, v80
  v_subrev_f32 v95, s95, v80
  v_subrev_f32 v96, s96, v80
  v_subrev_f32 v97, s97, v80
  v_subrev_f32 v98, s98, v80
  v_subrev_f32 v99, s99, v80
  v_mul_f32 v92, v92, v92
  v_mul_f32 v93, v93, v93
  v_mul_f32 v94, v94, v94
  v_mul_f32 v95, v95, v95
  v_mul_f32 v96, v96, v96
  v_mul_f32 v97, v97, v97
  v_mul_f32 v98, v98, v98
  v_mul_f32 v99, v99, v99
  v_mul_f32 v92, s46, v92
  v_mul_f32 v93, s46, v93
  v_mul_f32 v94, s46, v94
  v_mul_f32 v95, s46, v95
  v_mul_f32 v96, s46, v96
  v_mul_f32 v97, s46, v97
  v_mul_f32 v98, s46, v98
  v_mul_f32 v99, s46, v99
  v_exp_f32 v92, v92
  v_exp_f32 v93, v93
  v_exp_f32 v94, v94
  v_exp_f32 v95, v95
  v_exp_f32 v96, v96
  v_exp_f32 v97, v97
  v_exp_f32 v98, v98
  v_exp_f32 v99, v99
  s_nop 0
  v_cvt_pk_bf16_f32 v100, v92, v93
  v_cvt_pk_bf16_f32 v101, v94, v95
  v_cvt_pk_bf16_f32 v102, v96, v97
  v_cvt_pk_bf16_f32 v103, v98, v99
  v_dot2_f32_bf16 v104, v100, s60, 0
  v_dot2_f32_bf16 v105, v100, s64, 0
  v_dot2_f32_bf16 v106, v100, s68, 0
  v_dot2_f32_bf16 v107, v100, s72, 0
  v_dot2_f32_bf16 v108, v100, s76, 0
  v_dot2_f32_bf16 v109, v100, s80, 0
  v_dot2_f32_bf16 v110, v100, s84, 0
  v_dot2_f32_bf16 v111, v100, s88, 0
  v_dot2_f32_bf16 v8, v100, s28, 0
  v_dot2_f32_bf16 v9, v100, s32, 0
  v_dot2_f32_bf16 v10, v100, s36, 0
  v_dot2_f32_bf16 v11, v100, s40, 0
  v_dot2_f32_bf16 v104, v101, s61, v104
  v_dot2_f32_bf16 v105, v101, s65, v105
  v_dot2_f32_bf16 v106, v101, s69, v106
  v_dot2_f32_bf16 v107, v101, s73, v107
  v_dot2_f32_bf16 v108, v101, s77, v108
  v_dot2_f32_bf16 v109, v101, s81, v109
  v_dot2_f32_bf16 v110, v101, s85, v110
  v_dot2_f32_bf16 v111, v101, s89, v111
  v_dot2_f32_bf16 v8, v101, s29, v8
  v_dot2_f32_bf16 v9, v101, s33, v9
  v_dot2_f32_bf16 v10, v101, s37, v10
  v_dot2_f32_bf16 v11, v101, s41, v11
  v_dot2_f32_bf16 v104, v102, s62, v104
  v_dot2_f32_bf16 v105, v102, s66, v105
  v_dot2_f32_bf16 v106, v102, s70, v106
  v_dot2_f32_bf16 v107, v102, s74, v107
  v_dot2_f32_bf16 v108, v102, s78, v108
  v_dot2_f32_bf16 v109, v102, s82, v109
  v_dot2_f32_bf16 v110, v102, s86, v110
  v_dot2_f32_bf16 v111, v102, s90, v111
  v_dot2_f32_bf16 v8, v102, s30, v8
  v_dot2_f32_bf16 v9, v102, s34, v9
  v_dot2_f32_bf16 v10, v102, s38, v10
  v_dot2_f32_bf16 v11, v102, s42, v11
  v_dot2_f32_bf16 v104, v103, s63, v104
  v_dot2_f32_bf16 v105, v103, s67, v105
  v_dot2_f32_bf16 v106, v103, s71, v106
  v_dot2_f32_bf16 v107, v103, s75, v107
  v_dot2_f32_bf16 v108, v103, s79, v108
  v_dot2_f32_bf16 v109, v103, s83, v109
  v_dot2_f32_bf16 v110, v103, s87, v110
  v_dot2_f32_bf16 v111, v103, s91, v111
  v_dot2_f32_bf16 v8, v103, s31, v8
  v_dot2_f32_bf16 v9, v103, s35, v9
  v_dot2_f32_bf16 v10, v103, s39, v10
  v_dot2_f32_bf16 v11, v103, s43, v11
  v_cvt_pk_bf16_f32 v92, v104, v108
  v_cvt_pk_bf16_f32 v93, v105, v109
  v_cvt_pk_bf16_f32 v94, v106, v110
  v_cvt_pk_bf16_f32 v95, v107, v111
  v_lshlrev_b32 v100, 4, v0
  ds_write_b128 v100, v[92:95] offset:0
  v_lshlrev_b32 v81, 16, v81
  v_subrev_f32 v92, s92, v81
  v_subrev_f32 v93, s93, v81
  v_subrev_f32 v94, s94, v81
  v_subrev_f32 v95, s95, v81
  v_subrev_f32 v96, s96, v81
  v_subrev_f32 v97, s97, v81
  v_subrev_f32 v98, s98, v81
  v_subrev_f32 v99, s99, v81
  v_mul_f32 v92, v92, v92
  v_mul_f32 v93, v93, v93
  v_mul_f32 v94, v94, v94
  v_mul_f32 v95, v95, v95
  v_mul_f32 v96, v96, v96
  v_mul_f32 v97, v97, v97
  v_mul_f32 v98, v98, v98
  v_mul_f32 v99, v99, v99
  v_mul_f32 v92, s46, v92
  v_mul_f32 v93, s46, v93
  v_mul_f32 v94, s46, v94
  v_mul_f32 v95, s46, v95
  v_mul_f32 v96, s46, v96
  v_mul_f32 v97, s46, v97
  v_mul_f32 v98, s46, v98
  v_mul_f32 v99, s46, v99
  v_exp_f32 v92, v92
  v_exp_f32 v93, v93
  v_exp_f32 v94, v94
  v_exp_f32 v95, v95
  v_exp_f32 v96, v96
  v_exp_f32 v97, v97
  v_exp_f32 v98, v98
  v_exp_f32 v99, v99
  s_nop 0
  v_cvt_pk_bf16_f32 v100, v92, v93
  v_cvt_pk_bf16_f32 v101, v94, v95
  v_cvt_pk_bf16_f32 v102, v96, v97
  v_cvt_pk_bf16_f32 v103, v98, v99
  v_dot2_f32_bf16 v104, v100, s60, 0
  v_dot2_f32_bf16 v105, v100, s64, 0
  v_dot2_f32_bf16 v106, v100, s68, 0
  v_dot2_f32_bf16 v107, v100, s72, 0
  v_dot2_f32_bf16 v108, v100, s76, 0
  v_dot2_f32_bf16 v109, v100, s80, 0
  v_dot2_f32_bf16 v110, v100, s84, 0
  v_dot2_f32_bf16 v111, v100, s88, 0
  v_dot2_f32_bf16 v12, v100, s28, 0
  v_dot2_f32_bf16 v13, v100, s32, 0
  v_dot2_f32_bf16 v14, v100, s36, 0
  v_dot2_f32_bf16 v15, v100, s40, 0
  v_dot2_f32_bf16 v104, v101, s61, v104
  v_dot2_f32_bf16 v105, v101, s65, v105
  v_dot2_f32_bf16 v106, v101, s69, v106
  v_dot2_f32_bf16 v107, v101, s73, v107
  v_dot2_f32_bf16 v108, v101, s77, v108
  v_dot2_f32_bf16 v109, v101, s81, v109
  v_dot2_f32_bf16 v110, v101, s85, v110
  v_dot2_f32_bf16 v111, v101, s89, v111
  v_dot2_f32_bf16 v12, v101, s29, v12
  v_dot2_f32_bf16 v13, v101, s33, v13
  v_dot2_f32_bf16 v14, v101, s37, v14
  v_dot2_f32_bf16 v15, v101, s41, v15
  v_dot2_f32_bf16 v104, v102, s62, v104
  v_dot2_f32_bf16 v105, v102, s66, v105
  v_dot2_f32_bf16 v106, v102, s70, v106
  v_dot2_f32_bf16 v107, v102, s74, v107
  v_dot2_f32_bf16 v108, v102, s78, v108
  v_dot2_f32_bf16 v109, v102, s82, v109
  v_dot2_f32_bf16 v110, v102, s86, v110
  v_dot2_f32_bf16 v111, v102, s90, v111
  v_dot2_f32_bf16 v12, v102, s30, v12
  v_dot2_f32_bf16 v13, v102, s34, v13
  v_dot2_f32_bf16 v14, v102, s38, v14
  v_dot2_f32_bf16 v15, v102, s42, v15
  v_dot2_f32_bf16 v104, v103, s63, v104
  v_dot2_f32_bf16 v105, v103, s67, v105
  v_dot2_f32_bf16 v106, v103, s71, v106
  v_dot2_f32_bf16 v107, v103, s75, v107
  v_dot2_f32_bf16 v108, v103, s79, v108
  v_dot2_f32_bf16 v109, v103, s83, v109
  v_dot2_f32_bf16 v110, v103, s87, v110
  v_dot2_f32_bf16 v111, v103, s91, v111
  v_dot2_f32_bf16 v12, v103, s31, v12
  v_dot2_f32_bf16 v13, v103, s35, v13
  v_dot2_f32_bf16 v14, v103, s39, v14
  v_dot2_f32_bf16 v15, v103, s43, v15
  v_cvt_pk_bf16_f32 v92, v104, v108
  v_cvt_pk_bf16_f32 v93, v105, v109
  v_cvt_pk_bf16_f32 v94, v106, v110
  v_cvt_pk_bf16_f32 v95, v107, v111
  v_lshlrev_b32 v100, 4, v0
  ds_write_b128 v100, v[92:95] offset:16384
  v_lshlrev_b32 v82, 16, v82
  v_subrev_f32 v92, s92, v82
  v_subrev_f32 v93, s93, v82
  v_subrev_f32 v94, s94, v82
  v_subrev_f32 v95, s95, v82
  v_subrev_f32 v96, s96, v82
  v_subrev_f32 v97, s97, v82
  v_subrev_f32 v98, s98, v82
  v_subrev_f32 v99, s99, v82
  v_mul_f32 v92, v92, v92
  v_mul_f32 v93, v93, v93
  v_mul_f32 v94, v94, v94
  v_mul_f32 v95, v95, v95
  v_mul_f32 v96, v96, v96
  v_mul_f32 v97, v97, v97
  v_mul_f32 v98, v98, v98
  v_mul_f32 v99, v99, v99
  v_mul_f32 v92, s46, v92
  v_mul_f32 v93, s46, v93
  v_mul_f32 v94, s46, v94
  v_mul_f32 v95, s46, v95
  v_mul_f32 v96, s46, v96
  v_mul_f32 v97, s46, v97
  v_mul_f32 v98, s46, v98
  v_mul_f32 v99, s46, v99
  v_exp_f32 v92, v92
  v_exp_f32 v93, v93
  v_exp_f32 v94, v94
  v_exp_f32 v95, v95
  v_exp_f32 v96, v96
  v_exp_f32 v97, v97
  v_exp_f32 v98, v98
  v_exp_f32 v99, v99
  s_nop 0
  v_cvt_pk_bf16_f32 v100, v92, v93
  v_cvt_pk_bf16_f32 v101, v94, v95
  v_cvt_pk_bf16_f32 v102, v96, v97
  v_cvt_pk_bf16_f32 v103, v98, v99
  v_dot2_f32_bf16 v104, v100, s60, 0
  v_dot2_f32_bf16 v105, v100, s64, 0
  v_dot2_f32_bf16 v106, v100, s68, 0
  v_dot2_f32_bf16 v107, v100, s72, 0
  v_dot2_f32_bf16 v108, v100, s76, 0
  v_dot2_f32_bf16 v109, v100, s80, 0
  v_dot2_f32_bf16 v110, v100, s84, 0
  v_dot2_f32_bf16 v111, v100, s88, 0
  v_dot2_f32_bf16 v16, v100, s28, 0
  v_dot2_f32_bf16 v17, v100, s32, 0
  v_dot2_f32_bf16 v18, v100, s36, 0
  v_dot2_f32_bf16 v19, v100, s40, 0
  v_dot2_f32_bf16 v104, v101, s61, v104
  v_dot2_f32_bf16 v105, v101, s65, v105
  v_dot2_f32_bf16 v106, v101, s69, v106
  v_dot2_f32_bf16 v107, v101, s73, v107
  v_dot2_f32_bf16 v108, v101, s77, v108
  v_dot2_f32_bf16 v109, v101, s81, v109
  v_dot2_f32_bf16 v110, v101, s85, v110
  v_dot2_f32_bf16 v111, v101, s89, v111
  v_dot2_f32_bf16 v16, v101, s29, v16
  v_dot2_f32_bf16 v17, v101, s33, v17
  v_dot2_f32_bf16 v18, v101, s37, v18
  v_dot2_f32_bf16 v19, v101, s41, v19
  v_dot2_f32_bf16 v104, v102, s62, v104
  v_dot2_f32_bf16 v105, v102, s66, v105
  v_dot2_f32_bf16 v106, v102, s70, v106
  v_dot2_f32_bf16 v107, v102, s74, v107
  v_dot2_f32_bf16 v108, v102, s78, v108
  v_dot2_f32_bf16 v109, v102, s82, v109
  v_dot2_f32_bf16 v110, v102, s86, v110
  v_dot2_f32_bf16 v111, v102, s90, v111
  v_dot2_f32_bf16 v16, v102, s30, v16
  v_dot2_f32_bf16 v17, v102, s34, v17
  v_dot2_f32_bf16 v18, v102, s38, v18
  v_dot2_f32_bf16 v19, v102, s42, v19
  v_dot2_f32_bf16 v104, v103, s63, v104
  v_dot2_f32_bf16 v105, v103, s67, v105
  v_dot2_f32_bf16 v106, v103, s71, v106
  v_dot2_f32_bf16 v107, v103, s75, v107
  v_dot2_f32_bf16 v108, v103, s79, v108
  v_dot2_f32_bf16 v109, v103, s83, v109
  v_dot2_f32_bf16 v110, v103, s87, v110
  v_dot2_f32_bf16 v111, v103, s91, v111
  v_dot2_f32_bf16 v16, v103, s31, v16
  v_dot2_f32_bf16 v17, v103, s35, v17
  v_dot2_f32_bf16 v18, v103, s39, v18
  v_dot2_f32_bf16 v19, v103, s43, v19
  v_cvt_pk_bf16_f32 v92, v104, v108
  v_cvt_pk_bf16_f32 v93, v105, v109
  v_cvt_pk_bf16_f32 v94, v106, v110
  v_cvt_pk_bf16_f32 v95, v107, v111
  v_lshlrev_b32 v100, 4, v0
  ds_write_b128 v100, v[92:95] offset:32768
  s_cmp_lg_u32 s3, 0
  s_cbranch_scc1 Lc_pro_done
  v_lshlrev_b32 v83, 16, v83
  v_subrev_f32 v92, s92, v83
  v_subrev_f32 v93, s93, v83
  v_subrev_f32 v94, s94, v83
  v_subrev_f32 v95, s95, v83
  v_subrev_f32 v96, s96, v83
  v_subrev_f32 v97, s97, v83
  v_subrev_f32 v98, s98, v83
  v_subrev_f32 v99, s99, v83
  v_mul_f32 v92, v92, v92
  v_mul_f32 v93, v93, v93
  v_mul_f32 v94, v94, v94
  v_mul_f32 v95, v95, v95
  v_mul_f32 v96, v96, v96
  v_mul_f32 v97, v97, v97
  v_mul_f32 v98, v98, v98
  v_mul_f32 v99, v99, v99
  v_mul_f32 v92, s46, v92
  v_mul_f32 v93, s46, v93
  v_mul_f32 v94, s46, v94
  v_mul_f32 v95, s46, v95
  v_mul_f32 v96, s46, v96
  v_mul_f32 v97, s46, v97
  v_mul_f32 v98, s46, v98
  v_mul_f32 v99, s46, v99
  v_exp_f32 v92, v92
  v_exp_f32 v93, v93
  v_exp_f32 v94, v94
  v_exp_f32 v95, v95
  v_exp_f32 v96, v96
  v_exp_f32 v97, v97
  v_exp_f32 v98, v98
  v_exp_f32 v99, v99
  s_nop 0
  v_cvt_pk_bf16_f32 v100, v92, v93
  v_cvt_pk_bf16_f32 v101, v94, v95
  v_cvt_pk_bf16_f32 v102, v96, v97
  v_cvt_pk_bf16_f32 v103, v98, v99
  v_dot2_f32_bf16 v104, v100, s60, 0
  v_dot2_f32_bf16 v105, v100, s64, 0
  v_dot2_f32_bf16 v106, v100, s68, 0
  v_dot2_f32_bf16 v107, v100, s72, 0
  v_dot2_f32_bf16 v108, v100, s76, 0
  v_dot2_f32_bf16 v109, v100, s80, 0
  v_dot2_f32_bf16 v110, v100, s84, 0
  v_dot2_f32_bf16 v111, v100, s88, 0
  v_dot2_f32_bf16 v20, v100, s28, 0
  v_dot2_f32_bf16 v21, v100, s32, 0
  v_dot2_f32_bf16 v22, v100, s36, 0
  v_dot2_f32_bf16 v23, v100, s40, 0
  v_dot2_f32_bf16 v104, v101, s61, v104
  v_dot2_f32_bf16 v105, v101, s65, v105
  v_dot2_f32_bf16 v106, v101, s69, v106
  v_dot2_f32_bf16 v107, v101, s73, v107
  v_dot2_f32_bf16 v108, v101, s77, v108
  v_dot2_f32_bf16 v109, v101, s81, v109
  v_dot2_f32_bf16 v110, v101, s85, v110
  v_dot2_f32_bf16 v111, v101, s89, v111
  v_dot2_f32_bf16 v20, v101, s29, v20
  v_dot2_f32_bf16 v21, v101, s33, v21
  v_dot2_f32_bf16 v22, v101, s37, v22
  v_dot2_f32_bf16 v23, v101, s41, v23
  v_dot2_f32_bf16 v104, v102, s62, v104
  v_dot2_f32_bf16 v105, v102, s66, v105
  v_dot2_f32_bf16 v106, v102, s70, v106
  v_dot2_f32_bf16 v107, v102, s74, v107
  v_dot2_f32_bf16 v108, v102, s78, v108
  v_dot2_f32_bf16 v109, v102, s82, v109
  v_dot2_f32_bf16 v110, v102, s86, v110
  v_dot2_f32_bf16 v111, v102, s90, v111
  v_dot2_f32_bf16 v20, v102, s30, v20
  v_dot2_f32_bf16 v21, v102, s34, v21
  v_dot2_f32_bf16 v22, v102, s38, v22
  v_dot2_f32_bf16 v23, v102, s42, v23
  v_dot2_f32_bf16 v104, v103, s63, v104
  v_dot2_f32_bf16 v105, v103, s67, v105
  v_dot2_f32_bf16 v106, v103, s71, v106
  v_dot2_f32_bf16 v107, v103, s75, v107
  v_dot2_f32_bf16 v108, v103, s79, v108
  v_dot2_f32_bf16 v109, v103, s83, v109
  v_dot2_f32_bf16 v110, v103, s87, v110
  v_dot2_f32_bf16 v111, v103, s91, v111
  v_dot2_f32_bf16 v20, v103, s31, v20
  v_dot2_f32_bf16 v21, v103, s35, v21
  v_dot2_f32_bf16 v22, v103, s39, v22
  v_dot2_f32_bf16 v23, v103, s43, v23
  v_cvt_pk_bf16_f32 v92, v104, v108
  v_cvt_pk_bf16_f32 v93, v105, v109
  v_cvt_pk_bf16_f32 v94, v106, v110
  v_cvt_pk_bf16_f32 v95, v107, v111
  v_lshlrev_b32 v100, 4, v0
  v_cmp_gt_u32 vcc, 53, v0
  s_and_saveexec_b64 s[12:13], vcc
  ds_write_b128 v100, v[92:95] offset:49152
  s_mov_b64 exec, s[12:13]
Lc_pro_done:
  v_lshlrev_b32 v72, 2, v0
  v_add_u32 v72, 150016, v72
  v_mov_b32 v73, 0
  v_mov_b32 v74, 158016
  v_cmp_gt_u32 vcc, 1000, v0
  s_and_saveexec_b64 s[12:13], vcc
  s_waitcnt vmcnt(0)
  ds_write_b32 v72, v3
  ds_write_b32 v72, v4 offset:4000
  ds_write_b32 v74, v73
  s_mov_b64 exec, s[12:13]
  s_add_u32 s24, s4, 155648000
  s_addc_u32 s25, s5, 0
  s_mov_b32 s8, s24
  s_and_b32 s9, s25, 0xffff
  s_or_b32 s9, s9, 524288
  s_mov_b32 s10, 800000
  s_mov_b32 s11, 0x00020000
  s_waitcnt lgkmcnt(0)
  s_load_dwordx8 s[76:83], s[52:53], 0
  s_mov_b32 s40, s48
  s_and_b32 s41, s49, 0xffff
  s_mov_b32 s42, 6400000
  s_mov_b32 s43, 0x00020000
  s_mov_b32 s44, s54
  s_and_b32 s45, s55, 0xffff
  s_mov_b32 s46, 6400000
  s_mov_b32 s47, 0x00020000
  s_mul_i32 s48, s2, 25000
  v_lshlrev_b32 v76, 3, v0
  v_add_u32 v77, s48, v76
  v_add_u32 v86, 0, v77
  buffer_load_dwordx2 v[78:79], v86, s[40:43], 0 offen
  v_add_u32 v87, 8192, v77
  buffer_load_dwordx2 v[80:81], v87, s[40:43], 0 offen
  v_add_u32 v88, 16384, v77
  buffer_load_dwordx2 v[82:83], v88, s[40:43], 0 offen
  v_add_u32 v89, 24576, v77
  buffer_load_dwordx2 v[84:85], v89, s[40:43], 0 offen
  s_barrier
  s_mov_b32 s29, 0
  s_mov_b32 s36, 0
  s_mov_b32 s39, 0
  s_mov_b32 s54, 0
  s_mov_b32 s55, 0
  s_mov_b32 s56, 0
  s_mov_b32 s57, 0
  s_mov_b32 s28, 1
  v_mov_b32 v7, 158016
  v_mov_b32 v4, 1
  s_cmp_lg_u32 s29, 0
  s_cbranch_scc1 Lh0
Ln0:
  s_cmp_lt_u32 s28, 1
  s_cbranch_scc1 Lr0
  s_cmp_lg_u32 s36, 0
  s_cbranch_scc1 Lx0
  s_mov_b64 exec, 1
  ds_add_rtn_u32 v3, v7, v4
  s_waitcnt lgkmcnt(0)
  v_readfirstlane_b32 s35, v3
  s_mov_b64 exec, 1
  s_cmp_ge_u32 s35, 2000
  s_cbranch_scc1 Lx0
  s_lshl_b32 s38, s35, 2
  s_add_u32 s38, s38, 150016
  v_add_u32 v75, s38, v126
  ds_read_b32 v3, v75
  s_sub_u32 s38, s35, 1000
  s_cmp_ge_u32 s35, 1000
  s_cselect_b32 s38, s38, s35
  s_mul_i32 s30, s38, 153600
  s_mov_b32 s28, 0
  s_waitcnt lgkmcnt(0)
Lr0:
  v_readlane_b32 s33, v3, s28
  s_add_u32 s28, s28, 1
  s_lshr_b32 s29, s33, 16
  s_and_b32 s32, s33, 1
  s_bfe_u32 s38, s33, 0xf0001
  s_mul_i32 s38, s38, 12
  s_add_u32 s31, s30, s38
  s_add_u32 s30, s30, 153600
  s_cmp_eq_u32 s29, 0
  s_cbranch_scc1 Ln0
Lh0:
  s_min_u32 s34, s29, 64
  s_sub_u32 s29, s29, s34
  s_bfm_b64 s[12:13], s34, 0
  s_cmp_eq_u32 s34, 64
  s_cselect_b64 s[12:13], -1, s[12:13]
  s_mov_b64 s[20:21], s[12:13]
  s_mov_b64 exec, s[12:13]
  s_cmp_lg_u32 s32, 0
  s_cbranch_scc1 Lo0
  buffer_load_dwordx2 v[24:25], v1, s[4:7], s31 offen
  s_mov_b32 s60, 0xaaaaaaaa
  s_mov_b32 s61, 0xaaaaaaaa
  s_add_u32 s31, s31, 384
  s_branch Ld0
Lo0:
  buffer_load_dwordx2 v[24:25], v124, s[4:7], s31 offen
  s_mov_b32 s60, 0x55555555
  s_mov_b32 s61, 0x55555555
  s_add_u32 s31, s31, 384
  s_branch Ld0
Lx0:
  s_add_u32 s36, s36, 1
  s_mov_b64 s[12:13], 1
  s_mov_b64 s[20:21], 0
  s_mov_b64 exec, 1
  s_mov_b32 s60, 0xaaaaaaaa
  s_mov_b32 s61, 0xaaaaaaaa
  buffer_load_dwordx2 v[24:25], v1, s[4:7], 0 offen
Ld0:
  s_cmp_lg_u32 s29, 0
  s_cbranch_scc1 Lh1
Ln1:
  s_cmp_lt_u32 s28, 1
  s_cbranch_scc1 Lr1
  s_cmp_lg_u32 s36, 0
  s_cbranch_scc1 Lx1
  s_mov_b64 exec, 1
  ds_add_rtn_u32 v3, v7, v4
  s_waitcnt lgkmcnt(0)
  v_readfirstlane_b32 s35, v3
  s_mov_b64 exec, 1
  s_cmp_ge_u32 s35, 2000
  s_cbranch_scc1 Lx1
  s_lshl_b32 s38, s35, 2
  s_add_u32 s38, s38, 150016
  v_add_u32 v75, s38, v126
  ds_read_b32 v3, v75
  s_sub_u32 s38, s35, 1000
  s_cmp_ge_u32 s35, 1000
  s_cselect_b32 s38, s38, s35
  s_mul_i32 s30, s38, 153600
  s_mov_b32 s28, 0
  s_waitcnt lgkmcnt(0)
Lr1:
  v_readlane_b32 s33, v3, s28
  s_add_u32 s28, s28, 1
  s_lshr_b32 s29, s33, 16
  s_and_b32 s32, s33, 1
  s_bfe_u32 s38, s33, 0xf0001
  s_mul_i32 s38, s38, 12
  s_add_u32 s31, s30, s38
  s_add_u32 s30, s30, 153600
  s_cmp_eq_u32 s29, 0
  s_cbranch_scc1 Ln1
Lh1:
  s_min_u32 s34, s29, 64
  s_sub_u32 s29, s29, s34
  s_bfm_b64 s[14:15], s34, 0
  s_cmp_eq_u32 s34, 64
  s_cselect_b64 s[14:15], -1, s[14:15]
  s_mov_b64 s[22:23], s[14:15]
  s_mov_b64 exec, s[14:15]
  s_cmp_lg_u32 s32, 0
  s_cbranch_scc1 Lo1
  buffer_load_dwordx2 v[26:27], v1, s[4:7], s31 offen
  s_mov_b32 s62, 0xaaaaaaaa
  s_mov_b32 s63, 0xaaaaaaaa
  s_add_u32 s31, s31, 384
  s_branch Ld1
Lo1:
  buffer_load_dwordx2 v[26:27], v124, s[4:7], s31 offen
  s_mov_b32 s62, 0x55555555
  s_mov_b32 s63, 0x55555555
  s_add_u32 s31, s31, 384
  s_branch Ld1
Lx1:
  s_add_u32 s36, s36, 1
  s_mov_b64 s[14:15], 1
  s_mov_b64 s[22:23], 0
  s_mov_b64 exec, 1
  s_mov_b32 s62, 0xaaaaaaaa
  s_mov_b32 s63, 0xaaaaaaaa
  buffer_load_dwordx2 v[26:27], v1, s[4:7], 0 offen
Ld1:
  s_waitcnt vmcnt(1)
  s_mov_b64 exec, s[12:13]
  v_cndmask_b32_e64 v75, v25, v24, s[60:61]
  v_cndmask_b32_e64 v24, v24, v25, s[60:61]
  v_lshlrev_b32 v25, 16, v75
  v_and_b32 v75, 0xffff0000, v75
  v_cndmask_b32_e64 v25, v25, v75, s[60:61]
  v_and_b32 v72, 0xfffff, v24
  v_lshrrev_b32 v32, 17, v24
  buffer_load_dwordx2 v[36:37], v72, s[8:11], 0 idxen
  v_and_b32 v32, 0x7ff8, v32
  v_mul_f32 v73, v5, v25
  v_add_u32 v72, v32, v32
  v_mul_f32 v74, v6, v25
  ds_read_b128 v[40:43], v72
  v_fract_f32 v73, v73
  v_fract_f32 v74, v74
  v_cos_f32 v73, v73
  v_cos_f32 v74, v74
  v_add_u32 v33, 75000, v32
  v_cvt_pk_bf16_f32 v34, v73, v74
  s_cmp_lg_u32 s29, 0
  s_cbranch_scc1 Lh2
Ln2:
  s_cmp_lt_u32 s28, 1
  s_cbranch_scc1 Lr2
  s_cmp_lg_u32 s36, 0
  s_cbranch_scc1 Lx2
  s_mov_b64 exec, 1
  ds_add_rtn_u32 v3, v7, v4
  s_waitcnt lgkmcnt(0)
  v_readfirstlane_b32 s35, v3
  s_mov_b64 exec, 1
  s_cmp_ge_u32 s35, 2000
  s_cbranch_scc1 Lx2
  s_lshl_b32 s38, s35, 2
  s_add_u32 s38, s38, 150016
  v_add_u32 v75, s38, v126
  ds_read_b32 v3, v75
  s_sub_u32 s38, s35, 1000
  s_cmp_ge_u32 s35, 1000
  s_cselect_b32 s38, s38, s35
  s_mul_i32 s30, s38, 153600
  s_mov_b32 s28, 0
  s_waitcnt lgkmcnt(0)
Lr2:
  v_readlane_b32 s33, v3, s28
  s_add_u32 s28, s28, 1
  s_lshr_b32 s29, s33, 16
  s_and_b32 s32, s33, 1
  s_bfe_u32 s38, s33, 0xf0001
  s_mul_i32 s38, s38, 12
  s_add_u32 s31, s30, s38
  s_add_u32 s30, s30, 153600
  s_cmp_eq_u32 s29, 0
  s_cbranch_scc1 Ln2
Lh2:
  s_min_u32 s34, s29, 64
  s_sub_u32 s29, s29, s34
  s_bfm_b64 s[16:17], s34, 0
  s_cmp_eq_u32 s34, 64
  s_cselect_b64 s[16:17], -1, s[16:17]
  s_mov_b64 s[24:25], s[16:17]
  s_mov_b64 exec, s[16:17]
  s_cmp_lg_u32 s32, 0
  s_cbranch_scc1 Lo2
  buffer_load_dwordx2 v[28:29], v1, s[4:7], s31 offen
  s_mov_b32 s64, 0xaaaaaaaa
  s_mov_b32 s65, 0xaaaaaaaa
  s_add_u32 s31, s31, 384
  s_branch Ld2
Lo2:
  buffer_load_dwordx2 v[28:29], v124, s[4:7], s31 offen
  s_mov_b32 s64, 0x55555555
  s_mov_b32 s65, 0x55555555
  s_add_u32 s31, s31, 384
  s_branch Ld2
Lx2:
  s_add_u32 s36, s36, 1
  s_mov_b64 s[16:17], 1
  s_mov_b64 s[24:25], 0
  s_mov_b64 exec, 1
  s_mov_b32 s64, 0xaaaaaaaa
  s_mov_b32 s65, 0xaaaaaaaa
  buffer_load_dwordx2 v[28:29], v1, s[4:7], 0 offen
Ld2:
  s_waitcnt lgkmcnt(0)
Lc_loop:
  s_waitcnt vmcnt(2)
  s_mov_b64 exec, s[14:15]
  v_cndmask_b32_e64 v75, v27, v26, s[62:63]
  v_cndmask_b32_e64 v26, v26, v27, s[62:63]
  v_lshlrev_b32 v27, 16, v75
  v_and_b32 v75, 0xffff0000, v75
  v_cndmask_b32_e64 v27, v27, v75, s[62:63]
  v_and_b32 v72, 0xfffff, v26
  v_lshrrev_b32 v44, 17, v26
  buffer_load_dwordx2 v[48:49], v72, s[8:11], 0 idxen
  v_and_b32 v44, 0x7ff8, v44
  v_mul_f32 v73, v5, v27
  v_add_u32 v72, v44, v44
  v_mul_f32 v74, v6, v27
  ds_read_b128 v[52:55], v72
  v_fract_f32 v73, v73
  v_fract_f32 v74, v74
  v_cos_f32 v73, v73
  v_cos_f32 v74, v74
  v_add_u32 v45, 75000, v44
  v_cvt_pk_bf16_f32 v46, v73, v74
  s_cmp_lg_u32 s29, 0
  s_cbranch_scc1 Lh3
Ln3:
  s_cmp_lt_u32 s28, 1
  s_cbranch_scc1 Lr3
  s_cmp_lg_u32 s36, 0
  s_cbranch_scc1 Lx3
  s_mov_b64 exec, 1
  ds_add_rtn_u32 v3, v7, v4
  s_waitcnt lgkmcnt(0)
  v_readfirstlane_b32 s35, v3
  s_mov_b64 exec, 1
  s_cmp_ge_u32 s35, 2000
  s_cbranch_scc1 Lx3
  s_lshl_b32 s38, s35, 2
  s_add_u32 s38, s38, 150016
  v_add_u32 v75, s38, v126
  ds_read_b32 v3, v75
  s_sub_u32 s38, s35, 1000
  s_cmp_ge_u32 s35, 1000
  s_cselect_b32 s38, s38, s35
  s_mul_i32 s30, s38, 153600
  s_mov_b32 s28, 0
  s_waitcnt lgkmcnt(0)
Lr3:
  v_readlane_b32 s33, v3, s28
  s_add_u32 s28, s28, 1
  s_lshr_b32 s29, s33, 16
  s_and_b32 s32, s33, 1
  s_bfe_u32 s38, s33, 0xf0001
  s_mul_i32 s38, s38, 12
  s_add_u32 s31, s30, s38
  s_add_u32 s30, s30, 153600
  s_cmp_eq_u32 s29, 0
  s_cbranch_scc1 Ln3
Lh3:
  s_min_u32 s34, s29, 64
  s_sub_u32 s29, s29, s34
  s_bfm_b64 s[18:19], s34, 0
  s_cmp_eq_u32 s34, 64
  s_cselect_b64 s[18:19], -1, s[18:19]
  s_mov_b64 s[26:27], s[18:19]
  s_mov_b64 exec, s[18:19]
  s_cmp_lg_u32 s32, 0
  s_cbranch_scc1 Lo3
  buffer_load_dwordx2 v[30:31], v1, s[4:7], s31 offen
  s_mov_b32 s66, 0xaaaaaaaa
  s_mov_b32 s67, 0xaaaaaaaa
  s_add_u32 s31, s31, 384
  s_branch Ld3
Lo3:
  buffer_load_dwordx2 v[30:31], v124, s[4:7], s31 offen
  s_mov_b32 s66, 0x55555555
  s_mov_b32 s67, 0x55555555
  s_add_u32 s31, s31, 384
  s_branch Ld3
Lx3:
  s_add_u32 s36, s36, 1
  s_mov_b64 s[18:19], 1
  s_mov_b64 s[26:27], 0
  s_mov_b64 exec, 1
  s_mov_b32 s66, 0xaaaaaaaa
  s_mov_b32 s67, 0xaaaaaaaa
  buffer_load_dwordx2 v[30:31], v1, s[4:7], 0 offen
Ld3:
  s_waitcnt vmcnt(3) lgkmcnt(5)
  s_mov_b64 exec, s[20:21]
  v_dot2_f32_bf16 v64, v40, v34, 0
  v_dot2_f32_bf16 v65, v41, v34, 0
  v_dot2_f32_bf16 v66, v42, v34, 0
  v_dot2_f32_bf16 v67, v43, v34, 0
  v_lshlrev_b32 v68, 16, v36
  v_and_b32 v69, 0xffff0000, v36
  v_lshlrev_b32 v70, 16, v37
  v_and_b32 v71, 0xffff0000, v37
  v_mul_f32 v64, v68, v64
  v_mul_f32 v65, v69, v65
  v_mul_f32 v66, v70, v66
  v_mul_f32 v67, v71, v67
  v_cvt_f64_f32 v[56:57], v64
  v_cvt_f64_f32 v[58:59], v65
  v_cvt_f64_f32 v[60:61], v66
  v_cvt_f64_f32 v[62:63], v67
  ds_add_f64 v32, v[56:57] offset:50000
  ds_add_f64 v33, v[58:59]
  ds_add_f64 v33, v[60:61] offset:25000
  ds_add_f64 v33, v[62:63] offset:50000
  s_cmp_ge_u32 s36, 3
  s_cbranch_scc1 Lc_done
  s_waitcnt vmcnt(2)
  s_mov_b64 exec, s[16:17]
  v_cndmask_b32_e64 v75, v29, v28, s[64:65]
  v_cndmask_b32_e64 v28, v28, v29, s[64:65]
  v_lshlrev_b32 v29, 16, v75
  v_and_b32 v75, 0xffff0000, v75
  v_cndmask_b32_e64 v29, v29, v75, s[64:65]
  v_and_b32 v72, 0xfffff, v28
  v_lshrrev_b32 v32, 17, v28
  buffer_load_dwordx2 v[36:37], v72, s[8:11], 0 idxen
  v_and_b32 v32, 0x7ff8, v32
  v_mul_f32 v73, v5, v29
  v_add_u32 v72, v32, v32
  v_mul_f32 v74, v6, v29
  ds_read_b128 v[40:43], v72
  v_fract_f32 v73, v73
  v_fract_f32 v74, v74
  v_cos_f32 v73, v73
  v_cos_f32 v74, v74
  v_add_u32 v33, 75000, v32
  v_cvt_pk_bf16_f32 v34, v73, v74
  s_cmp_lg_u32 s29, 0
  s_cbranch_scc1 Lh4
Ln4:
  s_cmp_lt_u32 s28, 1
  s_cbranch_scc1 Lr4
  s_cmp_lg_u32 s36, 0
  s_cbranch_scc1 Lx4
  s_mov_b64 exec, 1
  ds_add_rtn_u32 v3, v7, v4
  s_waitcnt lgkmcnt(0)
  v_readfirstlane_b32 s35, v3
  s_mov_b64 exec, 1
  s_cmp_ge_u32 s35, 2000
  s_cbranch_scc1 Lx4
  s_lshl_b32 s38, s35, 2
  s_add_u32 s38, s38, 150016
  v_add_u32 v75, s38, v126
  ds_read_b32 v3, v75
  s_sub_u32 s38, s35, 1000
  s_cmp_ge_u32 s35, 1000
  s_cselect_b32 s38, s38, s35
  s_mul_i32 s30, s38, 153600
  s_mov_b32 s28, 0
  s_waitcnt lgkmcnt(0)
Lr4:
  v_readlane_b32 s33, v3, s28
  s_add_u32 s28, s28, 1
  s_lshr_b32 s29, s33, 16
  s_and_b32 s32, s33, 1
  s_bfe_u32 s38, s33, 0xf0001
  s_mul_i32 s38, s38, 12
  s_add_u32 s31, s30, s38
  s_add_u32 s30, s30, 153600
  s_cmp_eq_u32 s29, 0
  s_cbranch_scc1 Ln4
Lh4:
  s_min_u32 s34, s29, 64
  s_sub_u32 s29, s29, s34
  s_bfm_b64 s[12:13], s34, 0
  s_cmp_eq_u32 s34, 64
  s_cselect_b64 s[12:13], -1, s[12:13]
  s_mov_b64 s[20:21], s[12:13]
  s_mov_b64 exec, s[12:13]
  s_cmp_lg_u32 s32, 0
  s_cbranch_scc1 Lo4
  buffer_load_dwordx2 v[24:25], v1, s[4:7], s31 offen
  s_mov_b32 s60, 0xaaaaaaaa
  s_mov_b32 s61, 0xaaaaaaaa
  s_add_u32 s31, s31, 384
  s_branch Ld4
Lo4:
  buffer_load_dwordx2 v[24:25], v124, s[4:7], s31 offen
  s_mov_b32 s60, 0x55555555
  s_mov_b32 s61, 0x55555555
  s_add_u32 s31, s31, 384
  s_branch Ld4
Lx4:
  s_add_u32 s36, s36, 1
  s_mov_b64 s[12:13], 1
  s_mov_b64 s[20:21], 0
  s_mov_b64 exec, 1
  s_mov_b32 s60, 0xaaaaaaaa
  s_mov_b32 s61, 0xaaaaaaaa
  buffer_load_dwordx2 v[24:25], v1, s[4:7], 0 offen
Ld4:
  s_waitcnt vmcnt(3) lgkmcnt(5)
  s_mov_b64 exec, s[22:23]
  v_dot2_f32_bf16 v64, v52, v46, 0
  v_dot2_f32_bf16 v65, v53, v46, 0
  v_dot2_f32_bf16 v66, v54, v46, 0
  v_dot2_f32_bf16 v67, v55, v46, 0
  v_lshlrev_b32 v68, 16, v48
  v_and_b32 v69, 0xffff0000, v48
  v_lshlrev_b32 v70, 16, v49
  v_and_b32 v71, 0xffff0000, v49
  v_mul_f32 v64, v68, v64
  v_mul_f32 v65, v69, v65
  v_mul_f32 v66, v70, v66
  v_mul_f32 v67, v71, v67
  v_cvt_f64_f32 v[56:57], v64
  v_cvt_f64_f32 v[58:59], v65
  v_cvt_f64_f32 v[60:61], v66
  v_cvt_f64_f32 v[62:63], v67
  ds_add_f64 v44, v[56:57] offset:50000
  ds_add_f64 v45, v[58:59]
  ds_add_f64 v45, v[60:61] offset:25000
  ds_add_f64 v45, v[62:63] offset:50000
  s_cmp_ge_u32 s36, 3
  s_cbranch_scc1 Lc_done
  s_waitcnt vmcnt(2)
  s_mov_b64 exec, s[18:19]
  v_cndmask_b32_e64 v75, v31, v30, s[66:67]
  v_cndmask_b32_e64 v30, v30, v31, s[66:67]
  v_lshlrev_b32 v31, 16, v75
  v_and_b32 v75, 0xffff0000, v75
  v_cndmask_b32_e64 v31, v31, v75, s[66:67]
  v_and_b32 v72, 0xfffff, v30
  v_lshrrev_b32 v44, 17, v30
  buffer_load_dwordx2 v[48:49], v72, s[8:11], 0 idxen
  v_and_b32 v44, 0x7ff8, v44
  v_mul_f32 v73, v5, v31
  v_add_u32 v72, v44, v44
  v_mul_f32 v74, v6, v31
  ds_read_b128 v[52:55], v72
  v_fract_f32 v73, v73
  v_fract_f32 v74, v74
  v_cos_f32 v73, v73
  v_cos_f32 v74, v74
  v_add_u32 v45, 75000, v44
  v_cvt_pk_bf16_f32 v46, v73, v74
  s_cmp_lg_u32 s29, 0
  s_cbranch_scc1 Lh5
Ln5:
  s_cmp_lt_u32 s28, 1
  s_cbranch_scc1 Lr5
  s_cmp_lg_u32 s36, 0
  s_cbranch_scc1 Lx5
  s_mov_b64 exec, 1
  ds_add_rtn_u32 v3, v7, v4
  s_waitcnt lgkmcnt(0)
  v_readfirstlane_b32 s35, v3
  s_mov_b64 exec, 1
  s_cmp_ge_u32 s35, 2000
  s_cbranch_scc1 Lx5
  s_lshl_b32 s38, s35, 2
  s_add_u32 s38, s38, 150016
  v_add_u32 v75, s38, v126
  ds_read_b32 v3, v75
  s_sub_u32 s38, s35, 1000
  s_cmp_ge_u32 s35, 1000
  s_cselect_b32 s38, s38, s35
  s_mul_i32 s30, s38, 153600
  s_mov_b32 s28, 0
  s_waitcnt lgkmcnt(0)
Lr5:
  v_readlane_b32 s33, v3, s28
  s_add_u32 s28, s28, 1
  s_lshr_b32 s29, s33, 16
  s_and_b32 s32, s33, 1
  s_bfe_u32 s38, s33, 0xf0001
  s_mul_i32 s38, s38, 12
  s_add_u32 s31, s30, s38
  s_add_u32 s30, s30, 153600
  s_cmp_eq_u32 s29, 0
  s_cbranch_scc1 Ln5
Lh5:
  s_min_u32 s34, s29, 64
  s_sub_u32 s29, s29, s34
  s_bfm_b64 s[14:15], s34, 0
  s_cmp_eq_u32 s34, 64
  s_cselect_b64 s[14:15], -1, s[14:15]
  s_mov_b64 s[22:23], s[14:15]
  s_mov_b64 exec, s[14:15]
  s_cmp_lg_u32 s32, 0
  s_cbranch_scc1 Lo5
  buffer_load_dwordx2 v[26:27], v1, s[4:7], s31 offen
  s_mov_b32 s62, 0xaaaaaaaa
  s_mov_b32 s63, 0xaaaaaaaa
  s_add_u32 s31, s31, 384
  s_branch Ld5
Lo5:
  buffer_load_dwordx2 v[26:27], v124, s[4:7], s31 offen
  s_mov_b32 s62, 0x55555555
  s_mov_b32 s63, 0x55555555
  s_add_u32 s31, s31, 384
  s_branch Ld5
Lx5:
  s_add_u32 s36, s36, 1
  s_mov_b64 s[14:15], 1
  s_mov_b64 s[22:23], 0
  s_mov_b64 exec, 1
  s_mov_b32 s62, 0xaaaaaaaa
  s_mov_b32 s63, 0xaaaaaaaa
  buffer_load_dwordx2 v[26:27], v1, s[4:7], 0 offen
Ld5:
  s_waitcnt vmcnt(3) lgkmcnt(5)
  s_mov_b64 exec, s[24:25]
  v_dot2_f32_bf16 v64, v40, v34, 0
  v_dot2_f32_bf16 v65, v41, v34, 0
  v_dot2_f32_bf16 v66, v42, v34, 0
  v_dot2_f32_bf16 v67, v43, v34, 0
  v_lshlrev_b32 v68, 16, v36
  v_and_b32 v69, 0xffff0000, v36
  v_lshlrev_b32 v70, 16, v37
  v_and_b32 v71, 0xffff0000, v37
  v_mul_f32 v64, v68, v64
  v_mul_f32 v65, v69, v65
  v_mul_f32 v66, v70, v66
  v_mul_f32 v67, v71, v67
  v_cvt_f64_f32 v[56:57], v64
  v_cvt_f64_f32 v[58:59], v65
  v_cvt_f64_f32 v[60:61], v66
  v_cvt_f64_f32 v[62:63], v67
  ds_add_f64 v32, v[56:57] offset:50000
  ds_add_f64 v33, v[58:59]
  ds_add_f64 v33, v[60:61] offset:25000
  ds_add_f64 v33, v[62:63] offset:50000
  s_cmp_ge_u32 s36, 3
  s_cbranch_scc1 Lc_done
  s_waitcnt vmcnt(2)
  s_mov_b64 exec, s[12:13]
  v_cndmask_b32_e64 v75, v25, v24, s[60:61]
  v_cndmask_b32_e64 v24, v24, v25, s[60:61]
  v_lshlrev_b32 v25, 16, v75
  v_and_b32 v75, 0xffff0000, v75
  v_cndmask_b32_e64 v25, v25, v75, s[60:61]
  v_and_b32 v72, 0xfffff, v24
  v_lshrrev_b32 v32, 17, v24
  buffer_load_dwordx2 v[36:37], v72, s[8:11], 0 idxen
  v_and_b32 v32, 0x7ff8, v32
  v_mul_f32 v73, v5, v25
  v_add_u32 v72, v32, v32
  v_mul_f32 v74, v6, v25
  ds_read_b128 v[40:43], v72
  v_fract_f32 v73, v73
  v_fract_f32 v74, v74
  v_cos_f32 v73, v73
  v_cos_f32 v74, v74
  v_add_u32 v33, 75000, v32
  v_cvt_pk_bf16_f32 v34, v73, v74
  s_cmp_lg_u32 s29, 0
  s_cbranch_scc1 Lh6
Ln6:
  s_cmp_lt_u32 s28, 1
  s_cbranch_scc1 Lr6
  s_cmp_lg_u32 s36, 0
  s_cbranch_scc1 Lx6
  s_mov_b64 exec, 1
  ds_add_rtn_u32 v3, v7, v4
  s_waitcnt lgkmcnt(0)
  v_readfirstlane_b32 s35, v3
  s_mov_b64 exec, 1
  s_cmp_ge_u32 s35, 2000
  s_cbranch_scc1 Lx6
  s_lshl_b32 s38, s35, 2
  s_add_u32 s38, s38, 150016
  v_add_u32 v75, s38, v126
  ds_read_b32 v3, v75
  s_sub_u32 s38, s35, 1000
  s_cmp_ge_u32 s35, 1000
  s_cselect_b32 s38, s38, s35
  s_mul_i32 s30, s38, 153600
  s_mov_b32 s28, 0
  s_waitcnt lgkmcnt(0)
Lr6:
  v_readlane_b32 s33, v3, s28
  s_add_u32 s28, s28, 1
  s_lshr_b32 s29, s33, 16
  s_and_b32 s32, s33, 1
  s_bfe_u32 s38, s33, 0xf0001
  s_mul_i32 s38, s38, 12
  s_add_u32 s31, s30, s38
  s_add_u32 s30, s30, 153600
  s_cmp_eq_u32 s29, 0
  s_cbranch_scc1 Ln6
Lh6:
  s_min_u32 s34, s29, 64
  s_sub_u32 s29, s29, s34
  s_bfm_b64 s[16:17], s34, 0
  s_cmp_eq_u32 s34, 64
  s_cselect_b64 s[16:17], -1, s[16:17]
  s_mov_b64 s[24:25], s[16:17]
  s_mov_b64 exec, s[16:17]
  s_cmp_lg_u32 s32, 0
  s_cbranch_scc1 Lo6
  buffer_load_dwordx2 v[28:29], v1, s[4:7], s31 offen
  s_mov_b32 s64, 0xaaaaaaaa
  s_mov_b32 s65, 0xaaaaaaaa
  s_add_u32 s31, s31, 384
  s_branch Ld6
Lo6:
  buffer_load_dwordx2 v[28:29], v124, s[4:7], s31 offen
  s_mov_b32 s64, 0x55555555
  s_mov_b32 s65, 0x55555555
  s_add_u32 s31, s31, 384
  s_branch Ld6
Lx6:
  s_add_u32 s36, s36, 1
  s_mov_b64 s[16:17], 1
  s_mov_b64 s[24:25], 0
  s_mov_b64 exec, 1
  s_mov_b32 s64, 0xaaaaaaaa
  s_mov_b32 s65, 0xaaaaaaaa
  buffer_load_dwordx2 v[28:29], v1, s[4:7], 0 offen
Ld6:
  s_waitcnt vmcnt(3) lgkmcnt(5)
  s_mov_b64 exec, s[26:27]
  v_dot2_f32_bf16 v64, v52, v46, 0
  v_dot2_f32_bf16 v65, v53, v46, 0
  v_dot2_f32_bf16 v66, v54, v46, 0
  v_dot2_f32_bf16 v67, v55, v46, 0
  v_lshlrev_b32 v68, 16, v48
  v_and_b32 v69, 0xffff0000, v48
  v_lshlrev_b32 v70, 16, v49
  v_and_b32 v71, 0xffff0000, v49
  v_mul_f32 v64, v68, v64
  v_mul_f32 v65, v69, v65
  v_mul_f32 v66, v70, v66
  v_mul_f32 v67, v71, v67
  v_cvt_f64_f32 v[56:57], v64
  v_cvt_f64_f32 v[58:59], v65
  v_cvt_f64_f32 v[60:61], v66
  v_cvt_f64_f32 v[62:63], v67
  ds_add_f64 v44, v[56:57] offset:50000
  ds_add_f64 v45, v[58:59]
  ds_add_f64 v45, v[60:61] offset:25000
  ds_add_f64 v45, v[62:63] offset:50000
  s_cmp_ge_u32 s36, 3
  s_cbranch_scc0 Lc_loop
Lc_done:
  s_mov_b64 exec, -1
  s_waitcnt vmcnt(0) lgkmcnt(0)
  s_lshl_b32 s84, s76, 16
  s_and_b32 s85, s76, 0xffff0000
  s_lshl_b32 s86, s77, 16
  s_and_b32 s87, s77, 0xffff0000
  s_lshl_b32 s88, s78, 16
  s_and_b32 s89, s78, 0xffff0000
  s_lshl_b32 s90, s79, 16
  s_and_b32 s91, s79, 0xffff0000
  s_lshl_b32 s92, s80, 16
  s_and_b32 s93, s80, 0xffff0000
  s_lshl_b32 s94, s81, 16
  s_and_b32 s95, s81, 0xffff0000
  s_lshl_b32 s96, s82, 16
  s_and_b32 s97, s82, 0xffff0000
  s_lshl_b32 s98, s83, 16
  s_and_b32 s99, s83, 0xffff0000
  s_barrier
  v_add_u32 v90, 50000, v76
  v_add_u32 v91, 50000, v90
  ds_read_b64 v[92:93], v90
  ds_read_b64 v[94:95], v90 offset:25000
  ds_read_b64 v[96:97], v91
  ds_read_b64 v[98:99], v91 offset:25000
  s_waitcnt lgkmcnt(0)
  v_cvt_f32_f64 v100, v[92:93]
  v_cvt_f32_f64 v101, v[94:95]
  v_cvt_f32_f64 v102, v[96:97]
  v_cvt_f32_f64 v103, v[98:99]
  v_mul_f32 v104, s84, v100
  v_mul_f32 v105, s85, v100
  v_mul_f32 v106, s86, v100
  v_mul_f32 v107, s87, v100
  v_fmac_f32 v104, s88, v101
  v_fmac_f32 v105, s89, v101
  v_fmac_f32 v106, s90, v101
  v_fmac_f32 v107, s91, v101
  v_fmac_f32 v104, s92, v102
  v_fmac_f32 v105, s93, v102
  v_fmac_f32 v106, s94, v102
  v_fmac_f32 v107, s95, v102
  v_fmac_f32 v104, s96, v103
  v_fmac_f32 v105, s97, v103
  v_fmac_f32 v106, s98, v103
  v_fmac_f32 v107, s99, v103
  v_lshlrev_b32 v108, 16, v78
  v_and_b32 v109, 0xffff0000, v78
  v_lshlrev_b32 v110, 16, v79
  v_and_b32 v111, 0xffff0000, v79
  v_fmac_f32 v108, v104, v8
  v_fmac_f32 v109, v105, v9
  v_fmac_f32 v110, v106, v10
  v_fmac_f32 v111, v107, v11
  v_cvt_pk_bf16_f32 v104, v108, v109
  v_cvt_pk_bf16_f32 v105, v110, v111
  buffer_store_dwordx2 v[104:105], v86, s[44:47], 0 offen sc1
  v_add_u32 v90, 58192, v76
  v_add_u32 v91, 50000, v90
  ds_read_b64 v[92:93], v90
  ds_read_b64 v[94:95], v90 offset:25000
  ds_read_b64 v[96:97], v91
  ds_read_b64 v[98:99], v91 offset:25000
  s_waitcnt lgkmcnt(0)
  v_cvt_f32_f64 v100, v[92:93]
  v_cvt_f32_f64 v101, v[94:95]
  v_cvt_f32_f64 v102, v[96:97]
  v_cvt_f32_f64 v103, v[98:99]
  v_mul_f32 v104, s84, v100
  v_mul_f32 v105, s85, v100
  v_mul_f32 v106, s86, v100
  v_mul_f32 v107, s87, v100
  v_fmac_f32 v104, s88, v101
  v_fmac_f32 v105, s89, v101
  v_fmac_f32 v106, s90, v101
  v_fmac_f32 v107, s91, v101
  v_fmac_f32 v104, s92, v102
  v_fmac_f32 v105, s93, v102
  v_fmac_f32 v106, s94, v102
  v_fmac_f32 v107, s95, v102
  v_fmac_f32 v104, s96, v103
  v_fmac_f32 v105, s97, v103
  v_fmac_f32 v106, s98, v103
  v_fmac_f32 v107, s99, v103
  v_lshlrev_b32 v108, 16, v80
  v_and_b32 v109, 0xffff0000, v80
  v_lshlrev_b32 v110, 16, v81
  v_and_b32 v111, 0xffff0000, v81
  v_fmac_f32 v108, v104, v12
  v_fmac_f32 v109, v105, v13
  v_fmac_f32 v110, v106, v14
  v_fmac_f32 v111, v107, v15
  v_cvt_pk_bf16_f32 v104, v108, v109
  v_cvt_pk_bf16_f32 v105, v110, v111
  buffer_store_dwordx2 v[104:105], v87, s[44:47], 0 offen sc1
  v_add_u32 v90, 66384, v76
  v_add_u32 v91, 50000, v90
  ds_read_b64 v[92:93], v90
  ds_read_b64 v[94:95], v90 offset:25000
  ds_read_b64 v[96:97], v91
  ds_read_b64 v[98:99], v91 offset:25000
  s_waitcnt lgkmcnt(0)
  v_cvt_f32_f64 v100, v[92:93]
  v_cvt_f32_f64 v101, v[94:95]
  v_cvt_f32_f64 v102, v[96:97]
  v_cvt_f32_f64 v103, v[98:99]
  v_mul_f32 v104, s84, v100
  v_mul_f32 v105, s85, v100
  v_mul_f32 v106, s86, v100
  v_mul_f32 v107, s87, v100
  v_fmac_f32 v104, s88, v101
  v_fmac_f32 v105, s89, v101
  v_fmac_f32 v106, s90, v101
  v_fmac_f32 v107, s91, v101
  v_fmac_f32 v104, s92, v102
  v_fmac_f32 v105, s93, v102
  v_fmac_f32 v106, s94, v102
  v_fmac_f32 v107, s95, v102
  v_fmac_f32 v104, s96, v103
  v_fmac_f32 v105, s97, v103
  v_fmac_f32 v106, s98, v103
  v_fmac_f32 v107, s99, v103
  v_lshlrev_b32 v108, 16, v82
  v_and_b32 v109, 0xffff0000, v82
  v_lshlrev_b32 v110, 16, v83
  v_and_b32 v111, 0xffff0000, v83
  v_fmac_f32 v108, v104, v16
  v_fmac_f32 v109, v105, v17
  v_fmac_f32 v110, v106, v18
  v_fmac_f32 v111, v107, v19
  v_cvt_pk_bf16_f32 v104, v108, v109
  v_cvt_pk_bf16_f32 v105, v110, v111
  buffer_store_dwordx2 v[104:105], v88, s[44:47], 0 offen sc1
  s_cmp_lg_u32 s3, 0
  s_cbranch_scc1 Lc_end
  v_cmp_gt_u32 vcc, 53, v0
  s_and_saveexec_b64 s[22:23], vcc
  v_add_u32 v90, 74576, v76
  v_add_u32 v91, 50000, v90
  ds_read_b64 v[92:93], v90
  ds_read_b64 v[94:95], v90 offset:25000
  ds_read_b64 v[96:97], v91
  ds_read_b64 v[98:99], v91 offset:25000
  s_waitcnt lgkmcnt(0)
  v_cvt_f32_f64 v100, v[92:93]
  v_cvt_f32_f64 v101, v[94:95]
  v_cvt_f32_f64 v102, v[96:97]
  v_cvt_f32_f64 v103, v[98:99]
  v_mul_f32 v104, s84, v100
  v_mul_f32 v105, s85, v100
  v_mul_f32 v106, s86, v100
  v_mul_f32 v107, s87, v100
  v_fmac_f32 v104, s88, v101
  v_fmac_f32 v105, s89, v101
  v_fmac_f32 v106, s90, v101
  v_fmac_f32 v107, s91, v101
  v_fmac_f32 v104, s92, v102
  v_fmac_f32 v105, s93, v102
  v_fmac_f32 v106, s94, v102
  v_fmac_f32 v107, s95, v102
  v_fmac_f32 v104, s96, v103
  v_fmac_f32 v105, s97, v103
  v_fmac_f32 v106, s98, v103
  v_fmac_f32 v107, s99, v103
  v_lshlrev_b32 v108, 16, v84
  v_and_b32 v109, 0xffff0000, v84
  v_lshlrev_b32 v110, 16, v85
  v_and_b32 v111, 0xffff0000, v85
  v_fmac_f32 v108, v104, v20
  v_fmac_f32 v109, v105, v21
  v_fmac_f32 v110, v106, v22
  v_fmac_f32 v111, v107, v23
  v_cvt_pk_bf16_f32 v104, v108, v109
  v_cvt_pk_bf16_f32 v105, v110, v111
  buffer_store_dwordx2 v[104:105], v89, s[44:47], 0 offen sc1
Lc_end:
Lc_exit:
  s_endpgm
.section .rodata,"a"
.p2align 6
.amdhsa_kernel prod_kernel
  .amdhsa_next_free_vgpr 128
  .amdhsa_next_free_sgpr 102
  .amdhsa_accum_offset 128
  .amdhsa_group_segment_fixed_size 0
  .amdhsa_kernarg_size 112
  .amdhsa_user_sgpr_count 2
  .amdhsa_user_sgpr_kernarg_segment_ptr 1
  .amdhsa_system_sgpr_workgroup_id_x 1
  .amdhsa_float_denorm_mode_32 3
.end_amdhsa_kernel
.p2align 6
.amdhsa_kernel cons_kernel
  .amdhsa_next_free_vgpr 128
  .amdhsa_next_free_sgpr 102
  .amdhsa_accum_offset 128
  .amdhsa_group_segment_fixed_size 0
  .amdhsa_kernarg_size 112
  .amdhsa_user_sgpr_count 2
  .amdhsa_user_sgpr_kernarg_segment_ptr 1
  .amdhsa_system_sgpr_workgroup_id_x 1
  .amdhsa_float_denorm_mode_32 3
.end_amdhsa_kernel
```
